```python
import torch

def _softmax(x, axis=-1):
    return torch.softmax(x, dim=axis)
def _gelu(x):
    return torch.nn.functional.gelu(x, approximate="tanh")
def _silu(x):
    return torch.nn.functional.silu(x)
def _sigmoid(x):
    return torch.sigmoid(x)
def _layernorm(x, axis=-1, eps=1e-5):
    m = x.mean(dim=axis, keepdim=True)
    v = x.var(dim=axis, keepdim=True, unbiased=False)
    return (x - m) / torch.sqrt(v + eps)
def _scatter_add(tgt, idx, src, axis=0):
    return tgt.clone().index_add_(axis, idx, src)
def _segment_sum(src, seg, n):
    out = torch.zeros((n,) + src.shape[1:], dtype=src.dtype)
    return out.index_add_(0, seg, src)
def _pad(x, pw):
    flat = tuple(v for pair in reversed(pw) for v in pair)
    return torch.nn.functional.pad(x, flat)

kernel_name = 'gated_mix__linear_kernel_hedgehog__glu_gated_glu__prompt'

def setup_inputs():

    _w = (lambda a: (lambda t: t.to(torch.bfloat16) if t.is_floating_point() else t)(torch.as_tensor(a)))
    def _A_setup():
        B, S, D, H = 1, 2048, 512, 32
        Dh = D // H
        return {
            "x": _w((lambda *s: torch.randn(*s, dtype=torch.bfloat16) * 0.05)(B, S, D)),
            "wqkv": _w((lambda *s: torch.randn(*s, dtype=torch.bfloat16) * 0.8)(D, 3 * D)),
            "w_phi": _w((lambda *s: torch.randn(*s, dtype=torch.bfloat16) * 0.8)(H, Dh, Dh) * (Dh ** -0.5)),
            "wo": _w((lambda *s: torch.randn(*s, dtype=torch.bfloat16) * 0.1)(D, D)),
        }
    _A_in = _A_setup()

    def _B_setup():
        B, S, D, F = 1, 2048, 512, 1792
        return {
            "x": _w((lambda *s: torch.randn(*s, dtype=torch.bfloat16) * 0.05)(B, S, D)),
            "w_gate": _w((lambda *s: torch.randn(*s, dtype=torch.bfloat16) * 0.4)(D, F)),
            "w_up": _w((lambda *s: torch.randn(*s, dtype=torch.bfloat16) * 0.05)(D, F)),
            "w_down": _w((lambda *s: torch.randn(*s, dtype=torch.bfloat16) * 0.05)(F, D)),
        }
    _B_in = _B_setup()

    return {
        "A_x": _A_in["x"],
        "A_wqkv": _A_in["wqkv"],
        "A_w_phi": _A_in["w_phi"],
        "A_wo": _A_in["wo"],
        "B_x": _B_in["x"],
        "B_w_gate": _B_in["w_gate"],
        "B_w_up": _B_in["w_up"],
        "B_w_down": _B_in["w_down"],
        "gate_w": _w((lambda *s: torch.randn(*s, dtype=torch.bfloat16) * 0.05)(512) * 16.0),
    }

def reference(A_x, A_wqkv, A_w_phi, A_wo, B_x, B_w_gate, B_w_up, B_w_down, gate_w):
    def _A_ref(x, wqkv, w_phi, wo):
        B, S, D = x.shape
        H = 32; Dh = D // H
        qkv = (lambda x, *d: x.permute(*d))((x @ wqkv).reshape(B, S, 3, H, Dh), 2, 0, 3, 1, 4)
        q, k, v = qkv[0], qkv[1], qkv[2]
        pq = torch.einsum("bhsd,hdf->bhsf", q, w_phi)
        pk = torch.einsum("bhsd,hdf->bhsf", k, w_phi)
        phi_q = torch.concatenate([_softmax(pq, axis=-1), _softmax(-pq, axis=-1)], axis=-1)
        phi_k = torch.concatenate([_softmax(pk, axis=-1), _softmax(-pk, axis=-1)], axis=-1)
        kv = torch.einsum("bhsf,bhsd->bhfd", phi_k, v)
        z  = torch.einsum("bhsf->bhf", phi_k)
        num = torch.einsum("bhqf,bhfd->bhqd", phi_q, kv)
        den = torch.einsum("bhqf,bhf->bhq", phi_q, z)[..., None] + 1e-6
        o = num / den
        return (lambda x, *d: x.permute(*d))(o, 0, 2, 1, 3).reshape(B, S, D) @ wo

    def _B_ref(x, w_gate, w_up, w_down):
        g = torch.einsum("bsd,df->bsf", x, w_gate)
        u = torch.einsum("bsd,df->bsf", x, w_up)
        h = _sigmoid(g) * u
        return torch.einsum("bsf,fd->bsd", h, w_down)

    x = A_x
    g = _sigmoid((x * gate_w).sum(-1, keepdims=True))
    a = _A_ref(x, A_wqkv, A_w_phi, A_wo)
    b = _B_ref(x, B_w_gate, B_w_up, B_w_down)
    return g * a + (1 - g) * b
```

```asm
; @launch grid=(256,1,1) block=(512,1,1) lds=163840
.amdgcn_target "amdgcn-amd-amdhsa--gfx950"
.text
.globl gated_mix__linear_kernel_hedgehog__glu_gated_glu__prompt_kernel
.p2align 12
.fill 960, 4, 0xbf810000
.p2align 8
.type gated_mix__linear_kernel_hedgehog__glu_gated_glu__prompt_kernel,@function
gated_mix__linear_kernel_hedgehog__glu_gated_glu__prompt_kernel:
    s_cmp_ge_u32 s2, 256
    s_cbranch_scc1 L_exit
    s_load_dwordx16 s[4:19], s[0:1], 0
    s_load_dwordx8 s[20:27], s[0:1], 64
    v_lshrrev_b32 v1, 6, v0
    v_and_b32 v255, 63, v0
    v_readfirstlane_b32 s60, v1
    v_mov_b32 v254, 0
    s_getpc_b64 s[90:91]
LA_pc_1:
    s_bfe_u32 s87, s2, 0x20003
    s_lshl_b32 s87, s87, 3
    s_add_u32 s87, s87, s60
    s_mul_i32 s87, s87, 512
    s_bitcmp1_b32 s2, 6
    s_cselect_b32 s88, L_second-LA_pc_1, 0
    s_add_u32 s87, s87, s88
    v_lshl_add_u32 v0, v255, 7, s87
    v_min_u32 v0, LB_end-LA_pc_1-4, v0
    s_mov_b64 exec, 15
    global_load_dword v254, v0, s[90:91]
    s_mov_b64 exec, -1
    s_and_b32 s87, s2, 7
    s_lshr_b32 s88, s2, 3
    s_and_b32 s64, s87, 1
    s_lshl_b32 s64, s64, 3
    s_and_b32 s89, s88, 7
    s_add_u32 s64, s64, s89
    s_lshr_b32 s67, s87, 1
    s_lshl_b32 s67, s67, 2
    s_lshr_b32 s89, s88, 3
    s_add_u32 s67, s67, s89
    s_lshr_b32 s63, s67, 1
    s_lshl_b32 s65, s87, 2
    s_and_b32 s89, s88, 3
    s_add_u32 s65, s65, s89
    s_lshr_b32 s66, s88, 2
    v_lshrrev_b32 v0, 3, v255
    v_and_b32 v2, 7, v255
    v_lshrrev_b32 v3, 4, v255
    v_xor_b32 v1, v2, v3
    v_lshlrev_b32 v1, 4, v1
    v_lshl_add_u32 v248, v0, 10, v1
    v_xor_b32 v247, 64, v248
    v_add_u32 v247, 0x1c00, v247
    v_and_b32 v3, 1, v3
    s_movk_i32 s87, 3584
    v_lshlrev_b32 v1, 1, v3
    v_xor_b32 v1, v2, v1
    v_lshlrev_b32 v1, 4, v1
    v_mad_u32_u24 v253, v0, s87, v1
    v_xor_b32 v252, 64, v253
    v_lshlrev_b32 v4, 2, v3
    v_xor_b32 v4, v2, v4
    v_lshlrev_b32 v4, 4, v4
    v_lshl_add_u32 v251, v0, 10, v4
    v_add_u32 v250, 0x1c00, v251
    s_movk_i32 s88, 3072
    v_mad_u32_u24 v249, v0, s88, v4
    s_and_b32 s61, s60, 3
    s_lshr_b32 s62, s60, 2
    s_lshl_b32 s68, s60, 11
    s_bfe_u32 s100, s2, 0x30003
    s_lshr_b32 s87, s2, 6
    s_lshl_b32 s87, s87, 1
    s_add_u32 s100, s100, s87
    s_add_u32 s101, s100, s62
    s_add_u32 s3, s66, s65
    s_lshl_b32 s87, s64, 17
    s_lshl_b32 s88, s60, 14
    s_add_u32 s76, s87, s88
    s_mul_i32 s87, s60, 24576
    s_lshl_b32 s88, s63, 7
    s_add_u32 s77, s87, s88
    s_mul_i32 s89, s60, 28672
    s_bitcmp1_b32 s2, 6
    s_cbranch_scc1 LA_hb_2
    s_add_u32 s77, s77, 1024
    s_lshr_b32 s88, s63, 1
    s_mul_i32 s70, s88, 384
    s_and_b32 s88, s63, 1
    s_lshl_b32 s69, s88, 8
    s_add_u32 s69, s69, s70
    s_add_u32 s69, s69, s89
    s_lshl_b32 s88, s88, 6
    s_add_u32 s70, s70, s88
    s_mul_i32 s88, s61, 57344
    s_add_u32 s70, s70, s88
    s_add_u32 s70, s70, 128
    s_branch LA_hj_3
LA_hb_2:
    s_lshl_b32 s70, s63, 8
    s_add_u32 s69, s70, s89
    s_add_u32 s69, s69, 1536
    s_mul_i32 s88, s61, 57344
    s_add_u32 s70, s70, s88
    s_add_u32 s70, s70, 1664
LA_hj_3:
    s_waitcnt lgkmcnt(0)
    s_add_u32 s0, s100, 0
    s_and_b32 s0, s0, 7
    s_add_u32 s1, s100, 1
    s_and_b32 s1, s1, 7
    s_add_u32 s28, s4, s76
    s_addc_u32 s29, s5, 0
    s_sub_u32 s30, 2097152, s76
    s_mov_b32 s31, 0x20000
    s_add_u32 m0, s68, 0
    s_mul_i32 s76, s0, 128
    buffer_load_dwordx4 v248, s[28:31], s76 offen lds
    buffer_load_dwordx4 v247, s[28:31], s76 offen offset:1024 lds
    s_bitcmp1_b32 s2, 6
    s_cbranch_scc1 LA_hb_4
    s_add_u32 s32, s6, s77
    s_addc_u32 s33, s7, 0
    s_sub_u32 s34, 1572864, s77
    s_mov_b32 s35, 0x20000
    s_add_u32 m0, s68, 16384
    s_mul_i32 s76, s0, 196608
    buffer_load_dwordx4 v249, s[32:35], s76 offen lds
    buffer_load_dwordx4 v249, s[32:35], s76 offen offset:1024 lds
    s_branch LA_hj_5
LA_hb_4:
    s_add_u32 s36, s14, s69
    s_addc_u32 s37, s15, 0
    s_sub_u32 s38, 1835008, s69
    s_mov_b32 s39, 0x20000
    s_add_u32 s40, s16, s69
    s_addc_u32 s41, s17, 0
    s_sub_u32 s42, 1836032, s69
    s_sub_u32 s40, s40, 1024
    s_subb_u32 s41, s41, 0
    s_mov_b32 s43, 0x20000
    s_add_u32 m0, s68, 16384
    s_mul_i32 s76, s0, 229376
    buffer_load_dwordx4 v253, s[36:39], s76 offen lds
    buffer_load_dwordx4 v252, s[40:43], s76 offen offset:1024 lds
LA_hj_5:
    s_bitcmp1_b32 s2, 6
    s_cbranch_scc1 L_second
    s_add_u32 s36, s14, s69
    s_addc_u32 s37, s15, 0
    s_sub_u32 s38, 1835008, s69
    s_mov_b32 s39, 0x20000
    s_add_u32 s40, s16, s69
    s_addc_u32 s41, s17, 0
    s_sub_u32 s42, 1836032, s69
    s_sub_u32 s40, s40, 1024
    s_subb_u32 s41, s41, 0
    s_mov_b32 s43, 0x20000
    s_barrier
    s_mov_b32 s52, s26
    s_mov_b32 s53, s27
    s_mov_b32 s54, 10485760
    s_mov_b32 s55, 0x20000
    v_lshlrev_b32 v246, 4, v255
    v_mov_b32 v245, 0
    s_add_u32 m0, s68, 32768
    s_mul_i32 s76, s1, 128
    buffer_load_dwordx4 v248, s[28:31], s76 offen lds
    buffer_load_dwordx4 v247, s[28:31], s76 offen offset:1024 lds
    s_add_u32 m0, s68, 49152
    s_mul_i32 s76, s1, 196608
    buffer_load_dwordx4 v249, s[32:35], s76 offen lds
    buffer_load_dwordx4 v249, s[32:35], s76 offen offset:1024 lds
    s_mov_b32 s74, 0x3fb8aa3b
    s_mov_b32 s75, 0xbfb8aa3b
    s_lshl_b32 s87, s66, 7
    s_add_u32 s44, s18, s87
    s_addc_u32 s45, s19, 0
    s_sub_u32 s46, 1835008, s87
    s_mov_b32 s47, 0x20000
    s_add_u32 s48, s10, s87
    s_addc_u32 s49, s11, 0
    s_sub_u32 s50, 524288, s87
    s_mov_b32 s51, 0x20000
    s_lshl_b32 s88, s65, 16
    s_add_u32 s87, s87, s88
    s_add_u32 s56, s22, s87
    s_addc_u32 s57, s23, 0
    s_sub_u32 s58, 2097152, s87
    s_mov_b32 s59, 0x20000
    s_lshl_b32 s76, s63, 1
    s_add_u32 s76, s76, s62
    s_lshl_b32 s76, s76, 10
    s_mov_b32 s10, 16384
    s_mov_b32 s11, 0x20000
    s_add_u32 m0, s68, 65536
    s_nop 0
    buffer_load_dwordx4 v246, s[8:11], s76 offen lds
    s_add_u32 s12, s100, 2
    s_and_b32 s12, s12, 7
    s_add_u32 s13, s100, 3
    s_and_b32 s13, s13, 7
    s_add_u32 s18, s100, 4
    s_and_b32 s18, s18, 7
    s_add_u32 s19, s100, 5
    s_and_b32 s19, s19, 7
    s_add_u32 s22, s100, 6
    s_and_b32 s22, s22, 7
    s_add_u32 s23, s100, 7
    s_and_b32 s23, s23, 7
    s_add_u32 s6, s3, 0
    s_and_b32 s6, s6, 3
    s_lshl_b32 s6, s6, 14
    s_add_u32 s7, s3, 1
    s_and_b32 s7, s7, 3
    s_lshl_b32 s7, s7, 14
    s_add_u32 s26, s3, 2
    s_and_b32 s26, s26, 3
    s_lshl_b32 s26, s26, 14
    s_add_u32 s27, s3, 3
    s_and_b32 s27, s27, 3
    s_lshl_b32 s27, s27, 14
    s_lshl_b32 s71, s60, 17
    s_add_u32 s71, s71, 786432
    s_lshr_b32 s87, s60, 1
    s_mul_i32 s87, s87, 196608
    s_and_b32 s88, s60, 1
    s_lshl_b32 s98, s88, 17
    s_add_u32 s98, s98, s87
    s_lshl_b32 s73, s88, 15
    s_add_u32 s73, s73, s87
    s_add_u32 s73, s73, 65536
    s_lshl_b32 s72, s60, 16
    s_lshl_b32 s87, s64, 2
    s_add_u32 s87, s87, s61
    s_mul_i32 s87, s87, 144
    s_add_u32 s87, s87, s63
    s_lshl_b32 s87, s87, 10
    s_lshl_b32 s88, s62, 13
    s_add_u32 s80, s87, s88
    s_add_u32 s79, s80, s88
    s_lshl_b32 s87, s65, 1
    s_add_u32 s87, s87, s62
    s_mul_i32 s87, s87, 144
    s_lshl_b32 s88, s61, 1
    s_add_u32 s87, s87, s88
    s_lshl_b32 s81, s87, 10
    s_lshr_b32 s87, s64, 1
    s_mul_i32 s87, s87, 12288
    s_and_b32 s88, s64, 1
    s_mul_i32 s88, s88, 1280
    s_add_u32 s87, s87, s88
    s_add_u32 s84, s87, 9446656
    s_lshr_b32 s89, s65, 1
    s_lshr_b32 s87, s89, 1
    s_mul_i32 s87, s87, 12288
    s_and_b32 s88, s89, 1
    s_mul_i32 s88, s88, 1280
    s_add_u32 s87, s87, s88
    s_add_u32 s85, s87, 9446656
    s_mul_i32 s87, s63, 12288
    s_add_u32 s87, s87, 9437184
    s_add_u32 s86, s87, 9216
    s_mul_i32 s88, s61, 2304
    s_add_u32 s82, s87, s88
    s_lshl_b32 s88, s62, 6
    s_add_u32 s82, s82, s88
    s_lshl_b32 s87, s61, 12
    v_bfe_u32 v0, v255, 0, 5
    v_lshl_add_u32 v2, v0, 7, s87
    v_bfe_u32 v1, v255, 1, 3
    v_lshrrev_b32 v4, 5, v255
    v_xor_b32 v1, v1, v4
    v_lshl_add_u32 v2, v1, 4, v2
    v_xor_b32 v0, 32, v2
    v_xor_b32 v1, 64, v2
    v_xor_b32 v3, 0x60, v2
    v_bfe_u32 v4, v255, 5, 1
    v_lshlrev_b32 v5, 11, v4
    v_bfe_u32 v4, v255, 2, 2
    v_lshl_add_u32 v5, v4, 7, v5
    v_bfe_u32 v4, v255, 3, 1
    v_lshl_add_u32 v5, v4, 6, v5
    v_bfe_u32 v4, v255, 4, 1
    v_lshl_add_u32 v5, v4, 5, v5
    v_bfe_u32 v4, v255, 0, 2
    v_lshl_add_u32 v5, v4, 3, v5
    s_lshl_b32 s87, s62, 6
    v_xor_b32 v5, s87, v5
    s_waitcnt vmcnt(5)
    s_barrier
    ds_read_b128 v[240:243], v2
    ds_read_b64_tr_b16 v[8:9], v5 offset:16384
    ds_read_b64_tr_b16 v[10:11], v5 offset:16896
    ds_read_b64_tr_b16 v[12:13], v5 offset:17408
    ds_read_b64_tr_b16 v[14:15], v5 offset:17920
    ds_read_b128 v[236:239], v0
    ds_read_b64_tr_b16 v[16:17], v5 offset:20480
    ds_read_b64_tr_b16 v[18:19], v5 offset:20992
    s_waitcnt lgkmcnt(5)
    v_mfma_f32_32x32x16_bf16 v[220:235], v[8:11], v[240:243], 0
    ds_read_b64_tr_b16 v[8:9], v5 offset:21504
    ds_read_b64_tr_b16 v[10:11], v5 offset:22016
    s_waitcnt lgkmcnt(5)
    v_mfma_f32_32x32x16_bf16 v[204:219], v[12:15], v[240:243], 0
    ds_read_b128 v[200:203], v1
    ds_read_b64_tr_b16 v[12:13], v5 offset:24576
    ds_read_b64_tr_b16 v[14:15], v5 offset:25088
    s_waitcnt lgkmcnt(5)
    v_mfma_f32_32x32x16_bf16 v[220:235], v[16:19], v[236:239], v[220:235]
    ds_read_b64_tr_b16 v[16:17], v5 offset:25600
    ds_read_b64_tr_b16 v[18:19], v5 offset:26112
    s_waitcnt lgkmcnt(5)
    v_mfma_f32_32x32x16_bf16 v[204:219], v[8:11], v[236:239], v[204:219]
    ds_read_b128 v[196:199], v3
    ds_read_b64_tr_b16 v[8:9], v5 offset:28672
    ds_read_b64_tr_b16 v[10:11], v5 offset:29184
    s_waitcnt lgkmcnt(5)
    v_mfma_f32_32x32x16_bf16 v[220:235], v[12:15], v[200:203], v[220:235]
    ds_read_b64_tr_b16 v[12:13], v5 offset:29696
    ds_read_b64_tr_b16 v[14:15], v5 offset:30208
    s_waitcnt lgkmcnt(5)
    v_mfma_f32_32x32x16_bf16 v[204:219], v[16:19], v[200:203], v[204:219]
    s_waitcnt vmcnt(1) lgkmcnt(0)
    s_barrier
    ds_read_b128 v[192:195], v2 offset:32768
    ds_read_b64_tr_b16 v[16:17], v5 offset:49152
    ds_read_b64_tr_b16 v[18:19], v5 offset:49664
    v_mfma_f32_32x32x16_bf16 v[220:235], v[8:11], v[196:199], v[220:235]
    s_add_u32 m0, s68, 81920
    s_mul_i32 s76, s12, 128
    buffer_load_dwordx4 v248, s[28:31], s76 offen lds
    ds_read_b64_tr_b16 v[8:9], v5 offset:50176
    ds_read_b64_tr_b16 v[10:11], v5 offset:50688
    v_mfma_f32_32x32x16_bf16 v[204:219], v[12:15], v[196:199], v[204:219]
    buffer_load_dwordx4 v247, s[28:31], s76 offen offset:1024 lds
    ds_read_b128 v[188:191], v0 offset:32768
    ds_read_b64_tr_b16 v[12:13], v5 offset:53248
    ds_read_b64_tr_b16 v[14:15], v5 offset:53760
    s_waitcnt lgkmcnt(5)
    v_mfma_f32_32x32x16_bf16 v[220:235], v[16:19], v[192:195], v[220:235]
    s_add_u32 m0, s68, 98304
    s_mul_i32 s76, s12, 196608
    buffer_load_dwordx4 v249, s[32:35], s76 offen lds
    s_lshl_b32 s78, s61, 12
    s_add_u32 s78, s78, 81920
    v_bfe_u32 v4, v255, 0, 5
    v_lshl_add_u32 v6, v4, 7, s78
    ds_read_b64_tr_b16 v[16:17], v5 offset:54272
    ds_read_b64_tr_b16 v[18:19], v5 offset:54784
    s_waitcnt lgkmcnt(5)
    v_mfma_f32_32x32x16_bf16 v[204:219], v[8:11], v[192:195], v[204:219]
    buffer_load_dwordx4 v249, s[32:35], s76 offen offset:1024 lds
    v_bfe_u32 v4, v255, 3, 1
    ds_read_b128 v[184:187], v1 offset:32768
    ds_read_b64_tr_b16 v[8:9], v5 offset:57344
    ds_read_b64_tr_b16 v[10:11], v5 offset:57856
    s_waitcnt lgkmcnt(5)
    v_mfma_f32_32x32x16_bf16 v[220:235], v[12:15], v[188:191], v[220:235]
    s_add_u32 m0, s68, 114688
    s_mul_i32 s76, s13, 128
    buffer_load_dwordx4 v248, s[28:31], s76 offen lds
    v_lshl_add_u32 v6, v4, 6, v6
    v_bfe_u32 v4, v255, 1, 1
    ds_read_b64_tr_b16 v[12:13], v5 offset:58368
    ds_read_b64_tr_b16 v[14:15], v5 offset:58880
    s_waitcnt lgkmcnt(5)
    v_mfma_f32_32x32x16_bf16 v[204:219], v[16:19], v[188:191], v[204:219]
    buffer_load_dwordx4 v247, s[28:31], s76 offen offset:1024 lds
    v_lshl_add_u32 v6, v4, 5, v6
    v_bfe_u32 v4, v255, 2, 1
    ds_read_b128 v[180:183], v3 offset:32768
    ds_read_b64_tr_b16 v[16:17], v5 offset:61440
    ds_read_b64_tr_b16 v[18:19], v5 offset:61952
    s_waitcnt lgkmcnt(5)
    v_mfma_f32_32x32x16_bf16 v[220:235], v[8:11], v[184:187], v[220:235]
    v_lshl_add_u32 v6, v4, 4, v6
    ds_read_b64_tr_b16 v[8:9], v5 offset:62464
    ds_read_b64_tr_b16 v[10:11], v5 offset:62976
    s_waitcnt lgkmcnt(5)
    v_mfma_f32_32x32x16_bf16 v[204:219], v[12:15], v[184:187], v[204:219]
    v_bfe_u32 v4, v255, 0, 1
    v_lshl_add_u32 v6, v4, 3, v6
    s_waitcnt vmcnt(2) lgkmcnt(0)
    s_barrier
    v_add_u32 v4, 0x10000, v2
    ds_read_b128 v[176:179], v4 offset:16384
    v_add_u32 v7, 0x10000, v5
    ds_read_b64_tr_b16 v[12:13], v7 offset:32768
    ds_read_b64_tr_b16 v[14:15], v7 offset:33280
    v_mfma_f32_32x32x16_bf16 v[220:235], v[16:19], v[180:183], v[220:235]
    s_add_u32 m0, s68, 131072
    s_mul_i32 s76, s13, 196608
    buffer_load_dwordx4 v249, s[32:35], s76 offen lds
    v_lshrrev_b32 v16, 5, v255
    v_lshlrev_b32 v16, 3, v16
    ds_read_b64_tr_b16 v[20:21], v7 offset:33792
    ds_read_b64_tr_b16 v[22:23], v7 offset:34304
    v_mfma_f32_32x32x16_bf16 v[204:219], v[8:11], v[180:183], v[204:219]
    buffer_load_dwordx4 v249, s[32:35], s76 offen offset:1024 lds
    v_xor_b32 v6, v16, v6
    s_lshl_b32 s78, s62, 6
    v_xor_b32 v6, s78, v6
    v_add_u32 v8, 0x10000, v0
    ds_read_b128 v[172:175], v8 offset:16384
    ds_read_b64_tr_b16 v[16:17], v7 offset:36864
    ds_read_b64_tr_b16 v[18:19], v7 offset:37376
    s_waitcnt lgkmcnt(5)
    v_mfma_f32_32x32x16_bf16 v[220:235], v[12:15], v[176:179], v[220:235]
    s_add_u32 m0, s68, 147456
    s_mul_i32 s76, s18, 128
    buffer_load_dwordx4 v248, s[28:31], s76 offen lds
    s_mov_b32 s78, 81920
    s_cmp_lt_u32 s61, 2
    s_cselect_b32 s78, 65536, s78
    s_lshl_b32 s89, s61, 13
    s_add_u32 s78, s78, s89
    v_bfe_u32 v9, v255, 0, 5
    v_lshl_add_u32 v244, v9, 8, s78
    ds_read_b64_tr_b16 v[12:13], v7 offset:37888
    ds_read_b64_tr_b16 v[14:15], v7 offset:38400
    s_waitcnt lgkmcnt(5)
    v_mfma_f32_32x32x16_bf16 v[204:219], v[20:23], v[176:179], v[204:219]
    buffer_load_dwordx4 v247, s[28:31], s76 offen offset:1024 lds
    v_bfe_u32 v9, v255, 3, 1
    v_add_u32 v10, 0x10000, v1
    ds_read_b128 v[168:171], v10 offset:16384
    ds_read_b64_tr_b16 v[20:21], v7 offset:40960
    ds_read_b64_tr_b16 v[22:23], v7 offset:41472
    s_waitcnt lgkmcnt(5)
    v_mfma_f32_32x32x16_bf16 v[220:235], v[16:19], v[172:175], v[220:235]
    s_add_u32 m0, s68, 0
    s_mul_i32 s76, s18, 196608
    buffer_load_dwordx4 v249, s[32:35], s76 offen lds
    v_lshl_add_u32 v244, v9, 7, v244
    ds_read_b64_tr_b16 v[16:17], v7 offset:41984
    ds_read_b64_tr_b16 v[18:19], v7 offset:42496
    s_waitcnt lgkmcnt(5)
    v_mfma_f32_32x32x16_bf16 v[204:219], v[12:15], v[172:175], v[204:219]
    buffer_load_dwordx4 v249, s[32:35], s76 offen offset:1024 lds
    v_bfe_u32 v9, v255, 1, 1
    v_lshl_add_u32 v244, v9, 6, v244
    v_add_u32 v11, 0x10000, v3
    ds_read_b128 v[164:167], v11 offset:16384
    ds_read_b64_tr_b16 v[12:13], v7 offset:45056
    ds_read_b64_tr_b16 v[14:15], v7 offset:45568
    s_waitcnt lgkmcnt(5)
    v_mfma_f32_32x32x16_bf16 v[220:235], v[20:23], v[168:171], v[220:235]
    v_bfe_u32 v9, v255, 0, 1
    v_lshl_add_u32 v244, v9, 5, v244
    ds_read_b64_tr_b16 v[20:21], v7 offset:46080
    ds_read_b64_tr_b16 v[22:23], v7 offset:46592
    s_waitcnt lgkmcnt(5)
    v_mfma_f32_32x32x16_bf16 v[204:219], v[16:19], v[168:171], v[204:219]
    v_bfe_u32 v9, v255, 2, 1
    v_lshl_add_u32 v244, v9, 4, v244
    s_waitcnt vmcnt(4) lgkmcnt(0)
    s_barrier
    ds_read_b128 v[160:163], v4 offset:49152
    v_add_u32 v9, 0x20000, v5
    ds_read_b64_tr_b16 v[16:17], v9
    ds_read_b64_tr_b16 v[18:19], v9 offset:512
    v_mfma_f32_32x32x16_bf16 v[220:235], v[12:15], v[164:167], v[220:235]
    s_add_u32 m0, s68, 16384
    s_mul_i32 s76, s19, 128
    buffer_load_dwordx4 v248, s[28:31], s76 offen lds
    s_add_u32 s78, s68, 65536
    v_bfe_u32 v12, v255, 0, 1
    v_lshl_add_u32 v13, v12, 9, s78
    v_lshrrev_b32 v14, 5, v255
    v_lshlrev_b32 v14, 6, v14
    ds_read_b64_tr_b16 v[24:25], v9 offset:1024
    ds_read_b64_tr_b16 v[26:27], v9 offset:1536
    v_mfma_f32_32x32x16_bf16 v[204:219], v[20:23], v[164:167], v[204:219]
    buffer_load_dwordx4 v247, s[28:31], s76 offen offset:1024 lds
    v_bfe_u32 v12, v255, 5, 1
    v_lshl_add_u32 v13, v12, 7, v13
    v_bfe_u32 v12, v255, 2, 2
    v_xor_b32 v244, v14, v244
    s_lshl_b32 s78, s62, 7
    v_xor_b32 v244, s78, v244
    ds_read_b128 v[156:159], v8 offset:49152
    ds_read_b64_tr_b16 v[20:21], v9 offset:4096
    ds_read_b64_tr_b16 v[22:23], v9 offset:4608
    s_waitcnt lgkmcnt(5)
    v_mfma_f32_32x32x16_bf16 v[220:235], v[16:19], v[160:163], v[220:235]
    s_add_u32 m0, s68, 32768
    s_mul_i32 s76, s19, 196608
    buffer_load_dwordx4 v249, s[32:35], s76 offen lds
    v_lshl_add_u32 v13, v12, 5, v13
    v_bfe_u32 v12, v255, 4, 1
    ds_read_b64_tr_b16 v[16:17], v9 offset:5120
    ds_read_b64_tr_b16 v[18:19], v9 offset:5632
    s_waitcnt lgkmcnt(5)
    v_mfma_f32_32x32x16_bf16 v[204:219], v[24:27], v[160:163], v[204:219]
    buffer_load_dwordx4 v249, s[32:35], s76 offen offset:1024 lds
    v_lshl_add_u32 v13, v12, 4, v13
    v_bfe_u32 v12, v255, 1, 1
    ds_read_b128 v[152:155], v10 offset:49152
    ds_read_b64_tr_b16 v[24:25], v9 offset:8192
    ds_read_b64_tr_b16 v[26:27], v9 offset:8704
    s_waitcnt lgkmcnt(5)
    v_mfma_f32_32x32x16_bf16 v[220:235], v[20:23], v[156:159], v[220:235]
    s_add_u32 m0, s68, 49152
    s_mul_i32 s76, s22, 128
    buffer_load_dwordx4 v248, s[28:31], s76 offen lds
    v_lshl_add_u32 v13, v12, 3, v13
    ds_read_b64_tr_b16 v[20:21], v13
    ds_read_b64_tr_b16 v[22:23], v13 offset:256
    ds_read_b64_tr_b16 v[12:13], v9 offset:9216
    ds_read_b64_tr_b16 v[14:15], v9 offset:9728
    s_waitcnt lgkmcnt(7)
    v_mfma_f32_32x32x16_bf16 v[204:219], v[16:19], v[156:159], v[204:219]
    buffer_load_dwordx4 v247, s[28:31], s76 offen offset:1024 lds
    ds_read_b128 v[148:151], v11 offset:49152
    ds_read_b64_tr_b16 v[16:17], v9 offset:12288
    ds_read_b64_tr_b16 v[18:19], v9 offset:12800
    s_waitcnt lgkmcnt(7)
    v_mfma_f32_32x32x16_bf16 v[220:235], v[24:27], v[152:155], v[220:235]
    s_waitcnt lgkmcnt(6)
    v_lshlrev_b32 v24, 16, v20
    v_and_b32 v20, 0xffff0000, v20
    v_mul_f32 v24, s74, v24
    ds_read_b64_tr_b16 v[28:29], v9 offset:13312
    ds_read_b64_tr_b16 v[30:31], v9 offset:13824
    s_waitcnt lgkmcnt(5)
    v_mfma_f32_32x32x16_bf16 v[204:219], v[12:15], v[152:155], v[204:219]
    v_mul_f32 v20, s74, v20
    v_cvt_pk_bf16_f32 v20, v24, v20
    v_lshlrev_b32 v25, 16, v21
    s_waitcnt vmcnt(6) lgkmcnt(0)
    s_barrier
    v_add_u32 v9, 0x20000, v2
    ds_read_b128 v[144:147], v9 offset:16384
    ds_read_b64_tr_b16 v[12:13], v5
    ds_read_b64_tr_b16 v[14:15], v5 offset:512
    v_mfma_f32_32x32x16_bf16 v[220:235], v[16:19], v[148:151], v[220:235]
    s_add_u32 m0, s68, 81920
    s_mul_i32 s76, s22, 196608
    buffer_load_dwordx4 v249, s[32:35], s76 offen lds
    v_and_b32 v21, 0xffff0000, v21
    v_mul_f32 v25, s74, v25
    v_mul_f32 v21, s74, v21
    ds_read_b64_tr_b16 v[16:17], v5 offset:1024
    ds_read_b64_tr_b16 v[18:19], v5 offset:1536
    v_mfma_f32_32x32x16_bf16 v[204:219], v[28:31], v[148:151], v[204:219]
    buffer_load_dwordx4 v249, s[32:35], s76 offen offset:1024 lds
    v_cvt_pk_bf16_f32 v21, v25, v21
    v_lshlrev_b32 v26, 16, v22
    v_add_u32 v9, 0x20000, v0
    ds_read_b128 v[140:143], v9 offset:16384
    ds_read_b64_tr_b16 v[28:29], v5 offset:4096
    ds_read_b64_tr_b16 v[30:31], v5 offset:4608
    s_waitcnt lgkmcnt(5)
    v_mfma_f32_32x32x16_bf16 v[220:235], v[12:15], v[144:147], v[220:235]
    s_add_u32 m0, s68, 98304
    s_mul_i32 s76, s23, 128
    buffer_load_dwordx4 v248, s[28:31], s76 offen lds
    v_and_b32 v22, 0xffff0000, v22
    v_mul_f32 v26, s74, v26
    v_mul_f32 v22, s74, v22
    ds_read_b64_tr_b16 v[12:13], v5 offset:5120
    ds_read_b64_tr_b16 v[14:15], v5 offset:5632
    s_waitcnt lgkmcnt(5)
    v_mfma_f32_32x32x16_bf16 v[204:219], v[16:19], v[144:147], v[204:219]
    buffer_load_dwordx4 v247, s[28:31], s76 offen offset:1024 lds
    v_cvt_pk_bf16_f32 v22, v26, v22
    v_lshlrev_b32 v27, 16, v23
    v_and_b32 v23, 0xffff0000, v23
    v_add_u32 v9, 0x20000, v1
    ds_read_b128 v[136:139], v9 offset:16384
    ds_read_b64_tr_b16 v[16:17], v5 offset:8192
    ds_read_b64_tr_b16 v[18:19], v5 offset:8704
    s_waitcnt lgkmcnt(5)
    v_mfma_f32_32x32x16_bf16 v[220:235], v[28:31], v[140:143], v[220:235]
    s_add_u32 m0, s68, 65536
    s_mul_i32 s76, s23, 196608
    buffer_load_dwordx4 v249, s[32:35], s76 offen lds
    v_mul_f32 v27, s74, v27
    v_mul_f32 v23, s74, v23
    ds_read_b64_tr_b16 v[28:29], v5 offset:9216
    ds_read_b64_tr_b16 v[30:31], v5 offset:9728
    s_waitcnt lgkmcnt(5)
    v_mfma_f32_32x32x16_bf16 v[204:219], v[12:15], v[140:143], v[204:219]
    buffer_load_dwordx4 v249, s[32:35], s76 offen offset:1024 lds
    v_cvt_pk_bf16_f32 v23, v27, v23
    v_and_b32 v9, 4, v255
    v_cmp_eq_u32 s[90:91], 0, v9
    v_add_u32 v9, 0x20000, v3
    ds_read_b128 v[132:135], v9 offset:16384
    ds_read_b64_tr_b16 v[12:13], v5 offset:12288
    ds_read_b64_tr_b16 v[14:15], v5 offset:12800
    s_waitcnt lgkmcnt(5)
    v_mfma_f32_32x32x16_bf16 v[220:235], v[16:19], v[136:139], v[220:235]
    v_cndmask_b32 v128, 0, v20, s[90:91]
    v_cndmask_b32 v129, 0, v21, s[90:91]
    ds_read_b64_tr_b16 v[16:17], v5 offset:13312
    ds_read_b64_tr_b16 v[18:19], v5 offset:13824
    s_waitcnt lgkmcnt(5)
    v_mfma_f32_32x32x16_bf16 v[204:219], v[28:31], v[136:139], v[204:219]
    v_cndmask_b32 v130, 0, v22, s[90:91]
    v_cndmask_b32 v131, 0, v23, s[90:91]
    s_waitcnt vmcnt(8) lgkmcnt(0)
    s_barrier
    ds_read_b128 v[124:127], v2 offset:16384
    ds_read_b64_tr_b16 v[24:25], v5 offset:32768
    ds_read_b64_tr_b16 v[26:27], v5 offset:33280
    v_mfma_f32_32x32x16_bf16 v[220:235], v[12:15], v[132:135], v[220:235]
    s_add_u32 m0, s68, 114688
    s_mul_i32 s76, s0, 229376
    buffer_load_dwordx4 v253, s[36:39], s76 offen lds
    v_cndmask_b32 v120, v20, 0, s[90:91]
    v_cndmask_b32 v121, v21, 0, s[90:91]
    ds_read_b64_tr_b16 v[12:13], v5 offset:33792
    ds_read_b64_tr_b16 v[14:15], v5 offset:34304
    v_mfma_f32_32x32x16_bf16 v[204:219], v[16:19], v[132:135], v[204:219]
    buffer_load_dwordx4 v252, s[40:43], s76 offen offset:1024 lds
    v_cndmask_b32 v122, v22, 0, s[90:91]
    v_cndmask_b32 v123, v23, 0, s[90:91]
    ds_read_b128 v[116:119], v0 offset:16384
    ds_read_b64_tr_b16 v[16:17], v5 offset:36864
    ds_read_b64_tr_b16 v[18:19], v5 offset:37376
    s_waitcnt lgkmcnt(5)
    v_mfma_f32_32x32x16_bf16 v[220:235], v[24:27], v[124:127], v[220:235]
    v_bfe_u32 v9, v255, 2, 2
    v_lshlrev_b32 v249, 8, v9
    v_bfe_u32 v9, v255, 4, 2
    ds_read_b64_tr_b16 v[20:21], v5 offset:37888
    ds_read_b64_tr_b16 v[22:23], v5 offset:38400
    s_waitcnt lgkmcnt(5)
    v_mfma_f32_32x32x16_bf16 v[204:219], v[12:15], v[124:127], v[204:219]
    v_lshl_add_u32 v249, v9, 11, v249
    v_bfe_u32 v9, v255, 4, 1
    ds_read_b128 v[112:115], v1 offset:16384
    ds_read_b64_tr_b16 v[12:13], v5 offset:40960
    ds_read_b64_tr_b16 v[14:15], v5 offset:41472
    s_waitcnt lgkmcnt(5)
    v_mfma_f32_32x32x16_bf16 v[220:235], v[16:19], v[116:119], v[220:235]
    v_lshl_add_u32 v249, v9, 7, v249
    v_bfe_u32 v9, v255, 3, 1
    ds_read_b64_tr_b16 v[16:17], v5 offset:41984
    ds_read_b64_tr_b16 v[18:19], v5 offset:42496
    s_waitcnt lgkmcnt(5)
    v_mfma_f32_32x32x16_bf16 v[204:219], v[20:23], v[116:119], v[204:219]
    v_lshl_add_u32 v249, v9, 6, v249
    v_bfe_u32 v9, v255, 2, 1
    ds_read_b128 v[108:111], v3 offset:16384
    ds_read_b64_tr_b16 v[20:21], v5 offset:45056
    ds_read_b64_tr_b16 v[22:23], v5 offset:45568
    s_waitcnt lgkmcnt(5)
    v_mfma_f32_32x32x16_bf16 v[220:235], v[12:15], v[112:115], v[220:235]
    v_lshl_add_u32 v249, v9, 5, v249
    v_bfe_u32 v9, v255, 0, 1
    ds_read_b64_tr_b16 v[12:13], v5 offset:46080
    ds_read_b64_tr_b16 v[14:15], v5 offset:46592
    s_waitcnt lgkmcnt(5)
    v_mfma_f32_32x32x16_bf16 v[204:219], v[16:19], v[112:115], v[204:219]
    v_lshl_add_u32 v249, v9, 3, v249
    v_bfe_u32 v5, v255, 1, 1
    s_waitcnt vmcnt(6) lgkmcnt(0)
    s_barrier
    ds_read_b128 v[104:107], v2 offset:49152
    ds_read_b64_tr_b16 v[16:17], v7 offset:16384
    ds_read_b64_tr_b16 v[18:19], v7 offset:16896
    v_mfma_f32_32x32x16_bf16 v[220:235], v[20:23], v[108:111], v[220:235]
    s_add_u32 m0, s68, 131072
    s_mul_i32 s76, s1, 229376
    buffer_load_dwordx4 v253, s[36:39], s76 offen lds
    v_lshlrev_b32 v5, 4, v5
    v_xor_b32 v249, v5, v249
    ds_read_b64_tr_b16 v[20:21], v7 offset:17408
    ds_read_b64_tr_b16 v[22:23], v7 offset:17920
    v_mfma_f32_32x32x16_bf16 v[204:219], v[12:15], v[108:111], v[204:219]
    buffer_load_dwordx4 v252, s[40:43], s76 offen offset:1024 lds
    s_lshl_b32 s78, s61, 6
    s_lshl_b32 s89, s62, 5
    s_add_u32 s78, s78, s89
    v_xor_b32 v249, s78, v249
    v_bfe_u32 v2, v255, 2, 2
    ds_read_b128 v[100:103], v0 offset:49152
    ds_read_b64_tr_b16 v[12:13], v7 offset:20480
    ds_read_b64_tr_b16 v[14:15], v7 offset:20992
    s_waitcnt lgkmcnt(5)
    v_mfma_f32_32x32x16_bf16 v[220:235], v[16:19], v[104:107], v[220:235]
    s_add_u32 m0, s68, 147456
    s_mul_i32 s76, s12, 229376
    buffer_load_dwordx4 v253, s[36:39], s76 offen lds
    v_lshlrev_b32 v0, 7, v2
    v_bfe_u32 v2, v255, 4, 2
    ds_read_b64_tr_b16 v[16:17], v7 offset:21504
    ds_read_b64_tr_b16 v[18:19], v7 offset:22016
    s_waitcnt lgkmcnt(5)
    v_mfma_f32_32x32x16_bf16 v[204:219], v[20:23], v[104:107], v[204:219]
    buffer_load_dwordx4 v252, s[40:43], s76 offen offset:1024 lds
    v_lshl_add_u32 v0, v2, 10, v0
    v_bfe_u32 v2, v255, 4, 1
    ds_read_b128 v[96:99], v1 offset:49152
    ds_read_b64_tr_b16 v[20:21], v7 offset:24576
    ds_read_b64_tr_b16 v[22:23], v7 offset:25088
    s_waitcnt lgkmcnt(5)
    v_mfma_f32_32x32x16_bf16 v[220:235], v[12:15], v[100:103], v[220:235]
    s_add_u32 m0, s68, 0
    s_mul_i32 s76, s13, 229376
    buffer_load_dwordx4 v253, s[36:39], s76 offen lds
    v_lshl_add_u32 v0, v2, 6, v0
    v_bfe_u32 v2, v255, 3, 1
    ds_read_b64_tr_b16 v[12:13], v7 offset:25600
    ds_read_b64_tr_b16 v[14:15], v7 offset:26112
    s_waitcnt lgkmcnt(5)
    v_mfma_f32_32x32x16_bf16 v[204:219], v[16:19], v[100:103], v[204:219]
    buffer_load_dwordx4 v252, s[40:43], s76 offen offset:1024 lds
    v_lshl_add_u32 v0, v2, 5, v0
    v_bfe_u32 v2, v255, 2, 1
    ds_read_b128 v[92:95], v3 offset:49152
    ds_read_b64_tr_b16 v[16:17], v7 offset:28672
    ds_read_b64_tr_b16 v[18:19], v7 offset:29184
    s_waitcnt lgkmcnt(5)
    v_mfma_f32_32x32x16_bf16 v[220:235], v[20:23], v[96:99], v[220:235]
    v_lshl_add_u32 v0, v2, 3, v0
    v_and_b32 v5, 3, v255
    ds_read_b64_tr_b16 v[20:21], v7 offset:29696
    ds_read_b64_tr_b16 v[22:23], v7 offset:30208
    s_waitcnt lgkmcnt(5)
    v_mfma_f32_32x32x16_bf16 v[204:219], v[12:15], v[96:99], v[204:219]
    v_lshlrev_b32 v5, 3, v5
    v_xor_b32 v0, v5, v0
    s_lshl_b32 s78, s61, 5
    v_xor_b32 v0, s78, v0
    s_waitcnt vmcnt(8) lgkmcnt(0)
    s_barrier
    ds_read_b128 v[88:91], v4 offset:32768
    ds_read_b64_tr_b16 v[12:13], v7
    ds_read_b64_tr_b16 v[14:15], v7 offset:512
    v_mfma_f32_32x32x16_bf16 v[220:235], v[16:19], v[92:95], v[220:235]
    s_add_u32 m0, s68, 16384
    s_mul_i32 s76, s18, 229376
    buffer_load_dwordx4 v253, s[36:39], s76 offen lds
    v_bfe_u32 v1, v255, 4, 2
    v_lshlrev_b32 v2, 9, v1
    v_bfe_u32 v1, v255, 0, 4
    ds_read_b64_tr_b16 v[16:17], v7 offset:1024
    ds_read_b64_tr_b16 v[18:19], v7 offset:1536
    v_mfma_f32_32x32x16_bf16 v[204:219], v[20:23], v[92:95], v[204:219]
    buffer_load_dwordx4 v252, s[40:43], s76 offen offset:1024 lds
    v_lshl_add_u32 v2, v1, 2, v2
    ds_read_b128 v[84:87], v8 offset:32768
    ds_read_b64_tr_b16 v[20:21], v7 offset:4096
    ds_read_b64_tr_b16 v[22:23], v7 offset:4608
    s_waitcnt lgkmcnt(5)
    v_mfma_f32_32x32x16_bf16 v[220:235], v[12:15], v[88:91], v[220:235]
    s_add_u32 m0, s68, 32768
    s_mul_i32 s76, s19, 229376
    buffer_load_dwordx4 v253, s[36:39], s76 offen lds
    v_bfe_u32 v1, v255, 5, 1
    v_lshlrev_b32 v3, 11, v1
    v_bfe_u32 v1, v255, 4, 1
    ds_read_b64_tr_b16 v[12:13], v7 offset:5120
    ds_read_b64_tr_b16 v[14:15], v7 offset:5632
    s_waitcnt lgkmcnt(5)
    v_mfma_f32_32x32x16_bf16 v[204:219], v[16:19], v[88:91], v[204:219]
    buffer_load_dwordx4 v252, s[40:43], s76 offen offset:1024 lds
    v_lshl_add_u32 v3, v1, 10, v3
    v_bfe_u32 v1, v255, 2, 2
    ds_read_b128 v[80:83], v10 offset:32768
    ds_read_b64_tr_b16 v[16:17], v7 offset:8192
    ds_read_b64_tr_b16 v[18:19], v7 offset:8704
    s_waitcnt lgkmcnt(5)
    v_mfma_f32_32x32x16_bf16 v[220:235], v[20:23], v[84:87], v[220:235]
    v_lshl_add_u32 v3, v1, 7, v3
    v_bfe_u32 v1, v255, 0, 2
    v_lshl_add_u32 v3, v1, 3, v3
    ds_read_b64_tr_b16 v[20:21], v7 offset:9216
    ds_read_b64_tr_b16 v[22:23], v7 offset:9728
    s_waitcnt lgkmcnt(5)
    v_mfma_f32_32x32x16_bf16 v[204:219], v[12:15], v[84:87], v[204:219]
    v_bfe_u32 v1, v255, 3, 2
    v_lshl_add_u32 v3, v1, 5, v3
    ds_read_b128 v[76:79], v11 offset:32768
    ds_read_b64_tr_b16 v[8:9], v7 offset:12288
    ds_read_b64_tr_b16 v[10:11], v7 offset:12800
    s_waitcnt lgkmcnt(5)
    v_mfma_f32_32x32x16_bf16 v[220:235], v[16:19], v[80:83], v[220:235]
    s_lshl_b32 s87, s62, 6
    v_xor_b32 v3, s87, v3
    v_xor_b32 v1, 32, v3
    ds_read_b64_tr_b16 v[12:13], v7 offset:13312
    ds_read_b64_tr_b16 v[14:15], v7 offset:13824
    s_waitcnt lgkmcnt(5)
    v_mfma_f32_32x32x16_bf16 v[204:219], v[20:23], v[80:83], v[204:219]
    s_waitcnt vmcnt(8) lgkmcnt(0)
    s_barrier
    v_add_u32 v4, 0x10000, v3
    ds_read_b64_tr_b16 v[16:17], v4 offset:49152
    ds_read_b64_tr_b16 v[18:19], v4 offset:49664
    v_mfma_f32_32x32x16_bf16 v[220:235], v[8:11], v[76:79], v[220:235]
    s_mov_b32 s78, s2
    s_mul_i32 s99, s78, 9216
    s_lshl_b32 s89, s60, 7
    s_add_u32 s99, s99, s89
    s_sub_u32 s89, s99, 1835008
    s_cmp_lt_u32 s78, 200
    s_cselect_b32 s99, s99, s89
    s_cselect_b64 s[8:9], s[44:45], s[48:49]
    s_cselect_b32 s10, s46, s50
    v_lshlrev_b32 v5, 10, v255
    s_add_u32 s78, s2, 0
    s_and_b32 s78, s78, 0
    s_mul_i32 s78, s78, 9216
    s_add_u32 s78, s78, s99
    s_mov_b64 exec, 0x1ff
    buffer_load_dword v254, v5, s[8:11], s78 offen
    s_mov_b64 exec, -1
    v_add_u32 v5, 0x10000, v1
    ds_read_b64_tr_b16 v[8:9], v5 offset:49152
    ds_read_b64_tr_b16 v[10:11], v5 offset:49664
    v_mfma_f32_32x32x16_bf16 v[204:219], v[12:15], v[76:79], v[204:219]
    ds_read_b64_tr_b16 v[12:13], v4 offset:53248
    ds_read_b64_tr_b16 v[14:15], v4 offset:53760
    s_waitcnt lgkmcnt(4)
    v_mfma_f32_32x32x16_bf16 v[20:35], v[16:19], v[240:243], 0
    ds_read_b64_tr_b16 v[16:17], v5 offset:53248
    ds_read_b64_tr_b16 v[18:19], v5 offset:53760
    s_waitcnt lgkmcnt(4)
    v_mfma_f32_32x32x16_bf16 v[60:75], v[8:11], v[240:243], 0
    v_cvt_pk_bf16_f32 v220, v220, v221
    v_cvt_pk_bf16_f32 v221, v222, v223
    v_cvt_pk_bf16_f32 v222, v224, v225
    v_cvt_pk_bf16_f32 v223, v226, v227
    v_cvt_pk_bf16_f32 v224, v228, v229
    ds_read_b64_tr_b16 v[8:9], v4 offset:57344
    ds_read_b64_tr_b16 v[10:11], v4 offset:57856
    s_waitcnt lgkmcnt(4)
    v_mfma_f32_32x32x16_bf16 v[20:35], v[12:15], v[236:239], v[20:35]
    v_cvt_pk_bf16_f32 v225, v230, v231
    v_cvt_pk_bf16_f32 v226, v232, v233
    v_cvt_pk_bf16_f32 v227, v234, v235
    v_cvt_pk_bf16_f32 v204, v204, v205
    v_cvt_pk_bf16_f32 v205, v206, v207
    ds_read_b64_tr_b16 v[12:13], v5 offset:57344
    ds_read_b64_tr_b16 v[14:15], v5 offset:57856
    s_waitcnt lgkmcnt(4)
    v_mfma_f32_32x32x16_bf16 v[60:75], v[16:19], v[236:239], v[60:75]
    ds_write_b64 v6, v[204:205]
    v_xor_b32 v6, 16, v6
    v_cvt_pk_bf16_f32 v208, v208, v209
    v_cvt_pk_bf16_f32 v209, v210, v211
    ds_write_b64 v6, v[208:209]
    v_xor_b32 v6, 48, v6
    ds_read_b64_tr_b16 v[16:17], v4 offset:61440
    ds_read_b64_tr_b16 v[18:19], v4 offset:61952
    s_waitcnt lgkmcnt(6)
    v_mfma_f32_32x32x16_bf16 v[20:35], v[8:11], v[200:203], v[20:35]
    v_cvt_pk_bf16_f32 v212, v212, v213
    v_cvt_pk_bf16_f32 v213, v214, v215
    ds_write_b64 v6, v[212:213]
    v_xor_b32 v6, 16, v6
    v_cvt_pk_bf16_f32 v216, v216, v217
    v_cvt_pk_bf16_f32 v217, v218, v219
    ds_read_b64_tr_b16 v[8:9], v5 offset:61440
    ds_read_b64_tr_b16 v[10:11], v5 offset:61952
    s_waitcnt lgkmcnt(7)
    v_mfma_f32_32x32x16_bf16 v[60:75], v[12:15], v[200:203], v[60:75]
    v_bfe_u32 v7, v255, 0, 3
    v_lshlrev_b32 v12, 2, v7
    s_cmp_lg_u32 s60, 0
    s_cbranch_scc1 LA_np_8
    global_load_dword v7, v12, s[24:25] sc1
LA_np_8:
    ds_write_b64 v6, v[216:217]
    v_mfma_f32_32x32x16_bf16 v[204:219], v[128:131], v[220:223], 0
    v_mfma_f32_32x32x16_bf16 v[204:219], v[120:123], v[224:227], v[204:219]
    v_add_u32 v6, 0x20000, v3
    ds_read_b64_tr_b16 v[36:37], v6
    ds_read_b64_tr_b16 v[38:39], v6 offset:512
    s_waitcnt lgkmcnt(6)
    v_mfma_f32_32x32x16_bf16 v[20:35], v[16:19], v[196:199], v[20:35]
    s_add_u32 m0, s68, 49152
    s_mul_i32 s76, s22, 229376
    buffer_load_dwordx4 v253, s[36:39], s76 offen lds
    v_add_u32 v13, 0x20000, v1
    ds_read_b64_tr_b16 v[16:17], v13
    ds_read_b64_tr_b16 v[18:19], v13 offset:512
    s_waitcnt lgkmcnt(5)
    v_mfma_f32_32x32x16_bf16 v[60:75], v[8:11], v[196:199], v[60:75]
    buffer_load_dwordx4 v252, s[40:43], s76 offen offset:1024 lds
    v_max3_f32 v8, v204, v205, v206
    v_min3_f32 v9, v204, v205, v206
    v_max3_f32 v8, v8, v207, v208
    v_min3_f32 v9, v9, v207, v208
    v_max3_f32 v8, v8, v209, v210
    ds_read_b64_tr_b16 v[40:41], v6 offset:4096
    ds_read_b64_tr_b16 v[42:43], v6 offset:4608
    s_waitcnt lgkmcnt(4)
    v_mfma_f32_32x32x16_bf16 v[20:35], v[36:39], v[192:195], v[20:35]
    v_min3_f32 v9, v9, v209, v210
    v_max3_f32 v8, v8, v211, v212
    v_min3_f32 v9, v9, v211, v212
    v_max3_f32 v8, v8, v213, v214
    ds_read_b64_tr_b16 v[36:37], v13 offset:4096
    ds_read_b64_tr_b16 v[38:39], v13 offset:4608
    s_waitcnt lgkmcnt(4)
    v_mfma_f32_32x32x16_bf16 v[60:75], v[16:19], v[192:195], v[60:75]
    v_min3_f32 v9, v9, v213, v214
    v_max3_f32 v8, v8, v215, v216
    v_min3_f32 v9, v9, v215, v216
    v_max3_f32 v8, v8, v217, v218
    ds_read_b64_tr_b16 v[16:17], v6 offset:8192
    ds_read_b64_tr_b16 v[18:19], v6 offset:8704
    s_waitcnt lgkmcnt(4)
    v_mfma_f32_32x32x16_bf16 v[20:35], v[40:43], v[188:191], v[20:35]
    v_min3_f32 v9, v9, v217, v218
    v_max_f32 v8, v8, v219
    v_min_f32 v9, v9, v219
    v_sub_f32 v220, v204, v8
    v_sub_f32 v204, v9, v204
    ds_read_b64_tr_b16 v[40:41], v13 offset:8192
    ds_read_b64_tr_b16 v[42:43], v13 offset:8704
    s_waitcnt lgkmcnt(4)
    v_mfma_f32_32x32x16_bf16 v[60:75], v[36:39], v[188:191], v[60:75]
    v_sub_f32 v221, v205, v8
    v_sub_f32 v205, v9, v205
    v_exp_f32 v220, v220
    v_exp_f32 v204, v204
    ds_read_b64_tr_b16 v[36:37], v6 offset:12288
    ds_read_b64_tr_b16 v[38:39], v6 offset:12800
    s_waitcnt lgkmcnt(4)
    v_mfma_f32_32x32x16_bf16 v[20:35], v[16:19], v[184:187], v[20:35]
    v_sub_f32 v222, v206, v8
    v_sub_f32 v206, v9, v206
    v_exp_f32 v221, v221
    ds_read_b64_tr_b16 v[16:17], v13 offset:12288
    ds_read_b64_tr_b16 v[18:19], v13 offset:12800
    s_waitcnt lgkmcnt(4)
    v_mfma_f32_32x32x16_bf16 v[60:75], v[40:43], v[184:187], v[60:75]
    v_lshrrev_b32 v10, 2, v255
    s_movk_i32 s78, 3584
    v_mul_u32_u24 v11, s78, v10
    v_bfe_u32 v10, v255, 0, 2
    v_lshl_add_u32 v11, v10, 4, v11
    v_xor_b32 v10, 32, v11
    s_add_u32 s28, s14, s70
    s_addc_u32 s29, s15, 0
    s_sub_u32 s30, 1835008, s70
    s_mov_b32 s31, 0x20000
    s_add_u32 s32, s16, s70
    s_addc_u32 s33, s17, 0
    s_sub_u32 s34, 1836032, s70
    s_sub_u32 s32, s32, 1024
    s_subb_u32 s33, s33, 0
    s_mov_b32 s35, 0x20000
    v_exp_f32 v205, v205
    v_sub_f32 v223, v207, v8
    v_sub_f32 v207, v9, v207
    v_exp_f32 v222, v222
    s_waitcnt vmcnt(7) lgkmcnt(0)
    s_barrier
    ds_read_b64_tr_b16 v[40:41], v6 offset:16384
    ds_read_b64_tr_b16 v[42:43], v6 offset:16896
    v_mfma_f32_32x32x16_bf16 v[20:35], v[36:39], v[180:183], v[20:35]
    s_add_u32 m0, s68, 114688
    s_mul_i32 s76, s23, 229376
    buffer_load_dwordx4 v253, s[36:39], s76 offen lds
    v_exp_f32 v206, v206
    v_add_f32 v14, v220, v221
    v_add_f32 v15, v204, v205
    ds_read_b64_tr_b16 v[36:37], v13 offset:16384
    ds_read_b64_tr_b16 v[38:39], v13 offset:16896
    v_mfma_f32_32x32x16_bf16 v[60:75], v[16:19], v[180:183], v[60:75]
    buffer_load_dwordx4 v252, s[40:43], s76 offen offset:1024 lds
    v_sub_f32 v224, v208, v8
    v_sub_f32 v208, v9, v208
    v_exp_f32 v223, v223
    v_exp_f32 v207, v207
    ds_read_b64_tr_b16 v[16:17], v6 offset:20480
    ds_read_b64_tr_b16 v[18:19], v6 offset:20992
    s_waitcnt lgkmcnt(4)
    v_mfma_f32_32x32x16_bf16 v[20:35], v[40:43], v[176:179], v[20:35]
    s_add_u32 m0, s68, 131072
    s_add_u32 s76, s101, 0
    s_and_b32 s76, s76, 7
    s_mul_i32 s76, s76, 229376
    buffer_load_dwordx4 v11, s[28:31], s76 offen lds
    v_add_f32 v14, v14, v222
    v_add_f32 v15, v15, v206
    v_sub_f32 v225, v209, v8
    v_sub_f32 v209, v9, v209
    v_exp_f32 v224, v224
    ds_read_b64_tr_b16 v[40:41], v13 offset:20480
    ds_read_b64_tr_b16 v[42:43], v13 offset:20992
    s_waitcnt lgkmcnt(4)
    v_mfma_f32_32x32x16_bf16 v[60:75], v[36:39], v[176:179], v[60:75]
    buffer_load_dwordx4 v10, s[32:35], s76 offen offset:1024 lds
    v_exp_f32 v208, v208
    v_add_f32 v14, v14, v223
    ds_read_b64_tr_b16 v[36:37], v6 offset:24576
    ds_read_b64_tr_b16 v[38:39], v6 offset:25088
    s_waitcnt lgkmcnt(4)
    v_mfma_f32_32x32x16_bf16 v[20:35], v[16:19], v[172:175], v[20:35]
    v_add_f32 v15, v15, v207
    v_sub_f32 v226, v210, v8
    v_sub_f32 v210, v9, v210
    v_exp_f32 v225, v225
    v_exp_f32 v209, v209
    ds_read_b64_tr_b16 v[16:17], v13 offset:24576
    ds_read_b64_tr_b16 v[18:19], v13 offset:25088
    s_waitcnt lgkmcnt(4)
    v_mfma_f32_32x32x16_bf16 v[60:75], v[40:43], v[172:175], v[60:75]
    v_add_f32 v14, v14, v224
    v_add_f32 v15, v15, v208
    v_sub_f32 v227, v211, v8
    v_sub_f32 v211, v9, v211
    ds_read_b64_tr_b16 v[40:41], v6 offset:28672
    ds_read_b64_tr_b16 v[42:43], v6 offset:29184
    s_waitcnt lgkmcnt(4)
    v_mfma_f32_32x32x16_bf16 v[20:35], v[36:39], v[168:171], v[20:35]
    v_exp_f32 v226, v226
    v_exp_f32 v210, v210
    v_add_f32 v14, v14, v225
    ds_read_b64_tr_b16 v[36:37], v13 offset:28672
    ds_read_b64_tr_b16 v[38:39], v13 offset:29184
    s_waitcnt lgkmcnt(4)
    v_mfma_f32_32x32x16_bf16 v[60:75], v[16:19], v[168:171], v[60:75]
    v_add_f32 v15, v15, v209
    v_sub_f32 v228, v212, v8
    v_sub_f32 v212, v9, v212
    v_exp_f32 v227, v227
    ds_read_b64_tr_b16 v[16:17], v3
    ds_read_b64_tr_b16 v[18:19], v3 offset:512
    s_waitcnt lgkmcnt(4)
    v_mfma_f32_32x32x16_bf16 v[20:35], v[40:43], v[164:167], v[20:35]
    v_exp_f32 v211, v211
    v_add_f32 v14, v14, v226
    v_add_f32 v15, v15, v210
    v_sub_f32 v229, v213, v8
    v_sub_f32 v213, v9, v213
    ds_read_b64_tr_b16 v[40:41], v1
    ds_read_b64_tr_b16 v[42:43], v1 offset:512
    s_waitcnt lgkmcnt(4)
    v_mfma_f32_32x32x16_bf16 v[60:75], v[36:39], v[164:167], v[60:75]
    v_exp_f32 v228, v228
    v_exp_f32 v212, v212
    ds_read_b64_tr_b16 v[36:37], v3 offset:4096
    ds_read_b64_tr_b16 v[38:39], v3 offset:4608
    s_waitcnt lgkmcnt(4)
    v_mfma_f32_32x32x16_bf16 v[20:35], v[16:19], v[160:163], v[20:35]
    v_add_f32 v14, v14, v227
    v_add_f32 v15, v15, v211
    v_sub_f32 v230, v214, v8
    v_sub_f32 v214, v9, v214
    v_exp_f32 v229, v229
    ds_read_b64_tr_b16 v[16:17], v1 offset:4096
    ds_read_b64_tr_b16 v[18:19], v1 offset:4608
    s_waitcnt lgkmcnt(4)
    v_mfma_f32_32x32x16_bf16 v[60:75], v[40:43], v[160:163], v[60:75]
    v_exp_f32 v213, v213
    v_add_f32 v14, v14, v228
    v_add_f32 v15, v15, v212
    v_sub_f32 v231, v215, v8
    ds_read_b64_tr_b16 v[40:41], v3 offset:8192
    ds_read_b64_tr_b16 v[42:43], v3 offset:8704
    s_waitcnt lgkmcnt(4)
    v_mfma_f32_32x32x16_bf16 v[20:35], v[36:39], v[156:159], v[20:35]
    v_sub_f32 v215, v9, v215
    v_exp_f32 v230, v230
    v_exp_f32 v214, v214
    ds_read_b64_tr_b16 v[36:37], v1 offset:8192
    ds_read_b64_tr_b16 v[38:39], v1 offset:8704
    s_waitcnt lgkmcnt(4)
    v_mfma_f32_32x32x16_bf16 v[60:75], v[16:19], v[156:159], v[60:75]
    v_add_f32 v14, v14, v229
    v_add_f32 v15, v15, v213
    v_sub_f32 v232, v216, v8
    v_sub_f32 v216, v9, v216
    v_exp_f32 v231, v231
    ds_read_b64_tr_b16 v[16:17], v3 offset:12288
    ds_read_b64_tr_b16 v[18:19], v3 offset:12800
    s_waitcnt lgkmcnt(4)
    v_mfma_f32_32x32x16_bf16 v[20:35], v[40:43], v[152:155], v[20:35]
    v_exp_f32 v215, v215
    v_add_f32 v14, v14, v230
    v_add_f32 v15, v15, v214
    v_sub_f32 v233, v217, v8
    ds_read_b64_tr_b16 v[40:41], v1 offset:12288
    ds_read_b64_tr_b16 v[42:43], v1 offset:12800
    s_waitcnt lgkmcnt(4)
    v_mfma_f32_32x32x16_bf16 v[60:75], v[36:39], v[152:155], v[60:75]
    v_sub_f32 v217, v9, v217
    v_exp_f32 v232, v232
    v_exp_f32 v216, v216
    s_waitcnt vmcnt(7) lgkmcnt(0)
    s_cmp_lg_u32 s60, 0
    s_cbranch_scc1 LA_back_7
    s_waitcnt vmcnt(6)
    v_cmp_ne_u32 vcc, 0, v7
    s_nop 0
    s_cmp_eq_u64 vcc, -1
    s_cbranch_scc0 LA_slow_6
LA_back_7:
    s_barrier
    ds_read_b64_tr_b16 v[36:37], v3 offset:16384
    ds_read_b64_tr_b16 v[38:39], v3 offset:16896
    v_mfma_f32_32x32x16_bf16 v[20:35], v[16:19], v[148:151], v[20:35]
    s_add_u32 m0, s68, 147456
    s_add_u32 s76, s101, 2
    s_and_b32 s76, s76, 7
    s_mul_i32 s76, s76, 229376
    buffer_load_dwordx4 v11, s[28:31], s76 offen lds
    v_add_f32 v14, v14, v231
    v_add_f32 v15, v15, v215
    v_sub_f32 v234, v218, v8
    v_sub_f32 v218, v9, v218
    v_exp_f32 v233, v233
    ds_read_b64_tr_b16 v[16:17], v1 offset:16384
    ds_read_b64_tr_b16 v[18:19], v1 offset:16896
    v_mfma_f32_32x32x16_bf16 v[60:75], v[40:43], v[148:151], v[60:75]
    buffer_load_dwordx4 v10, s[32:35], s76 offen offset:1024 lds
    v_exp_f32 v217, v217
    v_add_f32 v14, v14, v232
    v_add_f32 v15, v15, v216
    ds_read_b64_tr_b16 v[40:41], v3 offset:20480
    ds_read_b64_tr_b16 v[42:43], v3 offset:20992
    s_waitcnt lgkmcnt(4)
    v_mfma_f32_32x32x16_bf16 v[20:35], v[36:39], v[144:147], v[20:35]
    v_sub_f32 v235, v219, v8
    v_sub_f32 v219, v9, v219
    v_exp_f32 v234, v234
    v_exp_f32 v218, v218
    ds_read_b64_tr_b16 v[36:37], v1 offset:20480
    ds_read_b64_tr_b16 v[38:39], v1 offset:20992
    s_waitcnt lgkmcnt(4)
    v_mfma_f32_32x32x16_bf16 v[60:75], v[16:19], v[144:147], v[60:75]
    v_add_f32 v14, v14, v233
    v_add_f32 v15, v15, v217
    v_exp_f32 v235, v235
    ds_read_b64_tr_b16 v[16:17], v3 offset:24576
    ds_read_b64_tr_b16 v[18:19], v3 offset:25088
    s_waitcnt lgkmcnt(4)
    v_mfma_f32_32x32x16_bf16 v[20:35], v[40:43], v[140:143], v[20:35]
    v_exp_f32 v219, v219
    v_add_f32 v14, v14, v234
    v_add_f32 v15, v15, v218
    v_add_f32 v14, v14, v235
    v_add_f32 v15, v15, v219
    ds_read_b64_tr_b16 v[40:41], v1 offset:24576
    ds_read_b64_tr_b16 v[42:43], v1 offset:25088
    s_waitcnt lgkmcnt(4)
    v_mfma_f32_32x32x16_bf16 v[60:75], v[36:39], v[140:143], v[60:75]
    v_rcp_f32 v14, v14
    v_rcp_f32 v15, v15
    ds_read_b64_tr_b16 v[36:37], v3 offset:28672
    ds_read_b64_tr_b16 v[38:39], v3 offset:29184
    s_waitcnt lgkmcnt(4)
    v_mfma_f32_32x32x16_bf16 v[20:35], v[16:19], v[136:139], v[20:35]
    v_mul_f32 v220, v14, v220
    v_mul_f32 v221, v14, v221
    v_cvt_pk_bf16_f32 v220, v220, v221
    v_mul_f32 v222, v14, v222
    v_mul_f32 v223, v14, v223
    v_cvt_pk_bf16_f32 v221, v222, v223
    ds_read_b64_tr_b16 v[16:17], v1 offset:28672
    ds_read_b64_tr_b16 v[18:19], v1 offset:29184
    s_waitcnt lgkmcnt(4)
    v_mfma_f32_32x32x16_bf16 v[60:75], v[40:43], v[136:139], v[60:75]
    v_mul_f32 v224, v14, v224
    v_mul_f32 v225, v14, v225
    v_cvt_pk_bf16_f32 v222, v224, v225
    v_mul_f32 v226, v14, v226
    v_mul_f32 v227, v14, v227
    ds_read_b64_tr_b16 v[40:41], v3 offset:32768
    ds_read_b64_tr_b16 v[42:43], v3 offset:33280
    s_waitcnt lgkmcnt(4)
    v_mfma_f32_32x32x16_bf16 v[20:35], v[36:39], v[132:135], v[20:35]
    s_add_u32 m0, s68, 0
    s_add_u32 s76, s101, 4
    s_and_b32 s76, s76, 7
    s_mul_i32 s76, s76, 229376
    buffer_load_dwordx4 v11, s[28:31], s76 offen lds
    v_cvt_pk_bf16_f32 v223, v226, v227
    v_mul_f32 v228, v14, v228
    v_mul_f32 v229, v14, v229
    v_cvt_pk_bf16_f32 v224, v228, v229
    v_mul_f32 v230, v14, v230
    v_mul_f32 v231, v14, v231
    ds_read_b64_tr_b16 v[36:37], v1 offset:32768
    ds_read_b64_tr_b16 v[38:39], v1 offset:33280
    s_waitcnt lgkmcnt(4)
    v_mfma_f32_32x32x16_bf16 v[60:75], v[16:19], v[132:135], v[60:75]
    buffer_load_dwordx4 v10, s[32:35], s76 offen offset:1024 lds
    v_cvt_pk_bf16_f32 v225, v230, v231
    v_mul_f32 v232, v14, v232
    ds_write_b128 v244, v[220:223]
    v_xor_b32 v244, 16, v244
    v_mul_f32 v233, v14, v233
    v_cvt_pk_bf16_f32 v226, v232, v233
    ds_read_b64_tr_b16 v[16:17], v3 offset:36864
    ds_read_b64_tr_b16 v[18:19], v3 offset:37376
    s_waitcnt lgkmcnt(5)
    v_mfma_f32_32x32x16_bf16 v[20:35], v[40:43], v[124:127], v[20:35]
    v_mul_f32 v234, v14, v234
    v_mul_f32 v235, v14, v235
    v_cvt_pk_bf16_f32 v227, v234, v235
    v_mul_f32 v204, v15, v204
    v_mul_f32 v205, v15, v205
    ds_read_b64_tr_b16 v[40:41], v1 offset:36864
    ds_read_b64_tr_b16 v[42:43], v1 offset:37376
    s_waitcnt lgkmcnt(5)
    v_mfma_f32_32x32x16_bf16 v[60:75], v[36:39], v[124:127], v[60:75]
    v_cvt_pk_bf16_f32 v228, v204, v205
    v_mul_f32 v206, v15, v206
    v_mul_f32 v207, v15, v207
    ds_write_b128 v244, v[224:227]
    v_xor_b32 v244, 48, v244
    v_cvt_pk_bf16_f32 v229, v206, v207
    ds_read_b64_tr_b16 v[36:37], v3 offset:40960
    ds_read_b64_tr_b16 v[38:39], v3 offset:41472
    s_waitcnt lgkmcnt(5)
    v_mfma_f32_32x32x16_bf16 v[20:35], v[16:19], v[116:119], v[20:35]
    v_mul_f32 v208, v15, v208
    v_mul_f32 v209, v15, v209
    v_cvt_pk_bf16_f32 v230, v208, v209
    v_mul_f32 v210, v15, v210
    v_mul_f32 v211, v15, v211
    ds_read_b64_tr_b16 v[16:17], v1 offset:40960
    ds_read_b64_tr_b16 v[18:19], v1 offset:41472
    s_waitcnt lgkmcnt(5)
    v_mfma_f32_32x32x16_bf16 v[60:75], v[40:43], v[116:119], v[60:75]
    v_cvt_pk_bf16_f32 v231, v210, v211
    v_mul_f32 v212, v15, v212
    v_mul_f32 v213, v15, v213
    v_cvt_pk_bf16_f32 v232, v212, v213
    ds_write_b128 v244, v[228:231]
    ds_read_b64_tr_b16 v[40:41], v3 offset:45056
    ds_read_b64_tr_b16 v[42:43], v3 offset:45568
    s_waitcnt lgkmcnt(5)
    v_mfma_f32_32x32x16_bf16 v[20:35], v[36:39], v[112:115], v[20:35]
    v_xor_b32 v244, 16, v244
    v_mul_f32 v214, v15, v214
    v_mul_f32 v215, v15, v215
    v_cvt_pk_bf16_f32 v233, v214, v215
    v_mul_f32 v216, v15, v216
    v_mul_f32 v217, v15, v217
    ds_read_b64_tr_b16 v[36:37], v1 offset:45056
    ds_read_b64_tr_b16 v[38:39], v1 offset:45568
    s_waitcnt lgkmcnt(5)
    v_mfma_f32_32x32x16_bf16 v[60:75], v[16:19], v[112:115], v[60:75]
    v_cvt_pk_bf16_f32 v234, v216, v217
    v_mul_f32 v218, v15, v218
    v_mul_f32 v219, v15, v219
    v_cvt_pk_bf16_f32 v235, v218, v219
    ds_write_b128 v244, v[232:235]
    s_waitcnt vmcnt(6) lgkmcnt(0)
    s_barrier
    ds_read_b64_tr_b16 v[12:13], v3 offset:49152
    ds_read_b64_tr_b16 v[14:15], v3 offset:49664
    v_mfma_f32_32x32x16_bf16 v[20:35], v[40:43], v[108:111], v[20:35]
    s_add_u32 m0, s68, 16384
    s_add_u32 s76, s101, 6
    s_and_b32 s76, s76, 7
    s_mul_i32 s76, s76, 229376
    buffer_load_dwordx4 v11, s[28:31], s76 offen lds
    v_xor_b32 v6, 16, v249
    s_waitcnt vmcnt(5)
    v_xor_b32 v7, 16, v0
    v_add_u32 v249, 0x10000, v249
    ds_read_b64_tr_b16 v[16:17], v249
    v_add_u32 v6, 0x10000, v6
    ds_read_b64_tr_b16 v[40:41], v1 offset:49152
    ds_read_b64_tr_b16 v[42:43], v1 offset:49664
    v_mfma_f32_32x32x16_bf16 v[60:75], v[36:39], v[108:111], v[60:75]
    buffer_load_dwordx4 v10, s[32:35], s76 offen offset:1024 lds
    ds_read_b64_tr_b16 v[18:19], v6 offset:1024
    v_add_u32 v0, 0x10000, v0
    ds_read_b64_tr_b16 v[8:9], v0 offset:16384
    v_add_u32 v7, 0x10000, v7
    ds_read_b64_tr_b16 v[10:11], v7 offset:16896
    ds_read_b64_tr_b16 v[36:37], v3 offset:53248
    ds_read_b64_tr_b16 v[38:39], v3 offset:53760
    s_waitcnt lgkmcnt(8)
    v_mfma_f32_32x32x16_bf16 v[20:35], v[12:15], v[104:107], v[20:35]
    s_add_u32 m0, s68, 32768
    s_add_u32 s76, s6, s71
    buffer_load_dwordx4 v251, s[44:47], s76 offen lds
    ds_read_b64_tr_b16 v[12:13], v249 offset:8192
    ds_read_b64_tr_b16 v[14:15], v6 offset:9216
    ds_read_b64_tr_b16 v[44:45], v0 offset:20480
    ds_read_b64_tr_b16 v[46:47], v7 offset:20992
    v_mov_b32 v48, 0x3f803f80
    ds_read_b64_tr_b16 v[52:53], v1 offset:53248
    ds_read_b64_tr_b16 v[54:55], v1 offset:53760
    s_waitcnt lgkmcnt(11)
    v_mfma_f32_32x32x16_bf16 v[60:75], v[40:43], v[104:107], v[60:75]
    buffer_load_dwordx4 v250, s[44:47], s76 offen offset:1024 lds
    s_waitcnt lgkmcnt(8)
    v_mfma_f32_16x16x32_bf16 v[40:43], v[8:11], v[16:19], 0
    v_mov_b32 v49, 0x3f803f80
    v_mov_b32 v50, 0x3f803f80
    v_mov_b32 v51, 0x3f803f80
    ds_read_b64_tr_b16 v[8:9], v3 offset:57344
    ds_read_b64_tr_b16 v[10:11], v3 offset:57856
    s_waitcnt lgkmcnt(8)
    v_mfma_f32_32x32x16_bf16 v[20:35], v[36:39], v[100:103], v[20:35]
    v_mfma_f32_16x16x32_bf16 v[36:39], v[48:51], v[16:19], 0
    ds_read_b64_tr_b16 v[16:17], v249 offset:32768
    ds_read_b64_tr_b16 v[18:19], v6 offset:33792
    ds_read_b64_tr_b16 v[56:57], v1 offset:57344
    ds_read_b64_tr_b16 v[58:59], v1 offset:57856
    s_waitcnt lgkmcnt(6)
    v_mfma_f32_32x32x16_bf16 v[60:75], v[52:55], v[100:103], v[60:75]
    v_mfma_f32_16x16x32_bf16 v[40:43], v[44:47], v[12:15], v[40:43]
    ds_read_b64_tr_b16 v[44:45], v0 offset:24576
    ds_read_b64_tr_b16 v[46:47], v7 offset:25088
    ds_read_b64_tr_b16 v[52:53], v3 offset:61440
    ds_read_b64_tr_b16 v[54:55], v3 offset:61952
    s_waitcnt lgkmcnt(8)
    v_mfma_f32_32x32x16_bf16 v[20:35], v[8:11], v[96:99], v[20:35]
    v_mfma_f32_16x16x32_bf16 v[36:39], v[48:51], v[12:15], v[36:39]
    ds_read_b64_tr_b16 v[8:9], v249 offset:40960
    ds_read_b64_tr_b16 v[10:11], v6 offset:41984
    ds_read_b64_tr_b16 v[12:13], v1 offset:61440
    ds_read_b64_tr_b16 v[14:15], v1 offset:61952
    s_waitcnt lgkmcnt(8)
    v_mfma_f32_32x32x16_bf16 v[60:75], v[56:59], v[96:99], v[60:75]
    s_waitcnt lgkmcnt(6)
    v_mfma_f32_16x16x32_bf16 v[40:43], v[44:47], v[16:19], v[40:43]
    ds_read_b64_tr_b16 v[44:45], v0 offset:28672
    ds_read_b64_tr_b16 v[46:47], v7 offset:29184
    ds_read_b64_tr_b16 v[56:57], v4 offset:49152
    ds_read_b64_tr_b16 v[58:59], v4 offset:49664
    s_waitcnt lgkmcnt(8)
    v_mfma_f32_32x32x16_bf16 v[20:35], v[52:55], v[92:95], v[20:35]
    v_mfma_f32_16x16x32_bf16 v[36:39], v[48:51], v[16:19], v[36:39]
    ds_read_b64_tr_b16 v[16:17], v5 offset:49152
    ds_read_b64_tr_b16 v[18:19], v5 offset:49664
    s_waitcnt lgkmcnt(6)
    v_mfma_f32_32x32x16_bf16 v[60:75], v[12:15], v[92:95], v[60:75]
    s_waitcnt lgkmcnt(4)
    v_mfma_f32_16x16x32_bf16 v[40:43], v[44:47], v[8:11], v[40:43]
    ds_read_b64_tr_b16 v[12:13], v4 offset:53248
    ds_read_b64_tr_b16 v[14:15], v4 offset:53760
    s_waitcnt lgkmcnt(4)
    v_mfma_f32_32x32x16_bf16 v[20:35], v[56:59], v[88:91], v[20:35]
    v_bfe_u32 v0, v255, 4, 1
    v_lshlrev_b32 v1, 10, v0
    v_bfe_u32 v0, v255, 5, 1
    v_mfma_f32_16x16x32_bf16 v[36:39], v[48:51], v[8:11], v[36:39]
    ds_read_b64_tr_b16 v[8:9], v5 offset:53248
    ds_read_b64_tr_b16 v[10:11], v5 offset:53760
    s_waitcnt lgkmcnt(4)
    v_mfma_f32_32x32x16_bf16 v[60:75], v[16:19], v[88:91], v[60:75]
    v_lshl_add_u32 v1, v0, 9, v1
    v_bfe_u32 v0, v255, 2, 2
    ds_read_b64_tr_b16 v[16:17], v4 offset:57344
    ds_read_b64_tr_b16 v[18:19], v4 offset:57856
    s_waitcnt lgkmcnt(4)
    v_mfma_f32_32x32x16_bf16 v[20:35], v[12:15], v[84:87], v[20:35]
    v_lshl_add_u32 v1, v0, 6, v1
    v_bfe_u32 v0, v255, 4, 1
    buffer_atomic_add_f32 v40, v2, s[52:55], s82 offen
    buffer_atomic_add_f32 v41, v2, s[52:55], s82 offen offset:128
    ds_read_b64_tr_b16 v[12:13], v5 offset:57344
    ds_read_b64_tr_b16 v[14:15], v5 offset:57856
    s_waitcnt lgkmcnt(4)
    v_mfma_f32_32x32x16_bf16 v[60:75], v[8:11], v[84:87], v[60:75]
    v_lshl_add_u32 v1, v0, 5, v1
    v_bfe_u32 v0, v255, 0, 2
    buffer_atomic_add_f32 v42, v2, s[52:55], s82 offen offset:256
    buffer_atomic_add_f32 v43, v2, s[52:55], s82 offen offset:384
    ds_read_b64_tr_b16 v[8:9], v4 offset:61440
    ds_read_b64_tr_b16 v[10:11], v4 offset:61952
    s_waitcnt lgkmcnt(4)
    v_mfma_f32_32x32x16_bf16 v[20:35], v[16:19], v[80:83], v[20:35]
    v_lshl_add_u32 v1, v0, 3, v1
    s_lshl_b32 s78, s62, 5
    v_xor_b32 v1, s78, v1
    s_mov_b64 exec, 0xffff
    buffer_atomic_add_f32 v36, v2, s[52:55], s82 offen offset:2048
    s_mov_b64 exec, -1
    ds_read_b64_tr_b16 v[16:17], v5 offset:61440
    ds_read_b64_tr_b16 v[18:19], v5 offset:61952
    s_waitcnt lgkmcnt(4)
    v_mfma_f32_32x32x16_bf16 v[60:75], v[12:15], v[80:83], v[60:75]
    s_waitcnt lgkmcnt(0)
    s_barrier
    s_cmp_lg_u32 s60, 0
    s_cbranch_scc1 LA_np_14
    buffer_load_dword v0, v245, s[52:55], s85 offen sc1
LA_np_14:
    v_add_u32 v2, 0x20000, v1
    ds_read_b64_tr_b16 v[4:5], v2
    ds_read_b64_tr_b16 v[6:7], v2 offset:256
    v_mfma_f32_32x32x16_bf16 v[20:35], v[8:11], v[76:79], v[20:35]
    s_add_u32 m0, s68, 49152
    s_add_u32 s76, s7, s71
    buffer_load_dwordx4 v251, s[44:47], s76 offen lds
    ds_read_b64_tr_b16 v[8:9], v2 offset:2048
    ds_read_b64_tr_b16 v[10:11], v2 offset:2304
    v_mfma_f32_32x32x16_bf16 v[60:75], v[16:19], v[76:79], v[60:75]
    buffer_load_dwordx4 v250, s[44:47], s76 offen offset:1024 lds
    ds_read_b64_tr_b16 v[12:13], v2 offset:4096
    ds_read_b64_tr_b16 v[14:15], v2 offset:4352
    s_waitcnt lgkmcnt(4)
    v_mfma_f32_32x32x16_bf16 v[36:51], v[4:7], v[240:243], 0
    s_add_u32 m0, s68, 114688
    s_add_u32 s76, s26, s71
    buffer_load_dwordx4 v251, s[44:47], s76 offen lds
    ds_read_b64_tr_b16 v[4:5], v2 offset:6144
    ds_read_b64_tr_b16 v[6:7], v2 offset:6400
    s_waitcnt lgkmcnt(4)
    v_mfma_f32_32x32x16_bf16 v[36:51], v[8:11], v[236:239], v[36:51]
    buffer_load_dwordx4 v250, s[44:47], s76 offen offset:1024 lds
    v_mul_f32 v20, s75, v20
    v_mul_f32 v21, s75, v21
    v_mul_f32 v22, s75, v22
    v_mul_f32 v23, s75, v23
    v_mul_f32 v24, s75, v24
    v_mul_f32 v25, s75, v25
    v_mul_f32 v26, s75, v26
    v_mul_f32 v27, s75, v27
    v_exp_f32 v20, v20
    v_exp_f32 v21, v21
    v_exp_f32 v22, v22
    ds_read_b64_tr_b16 v[8:9], v2 offset:8192
    ds_read_b64_tr_b16 v[10:11], v2 offset:8448
    s_waitcnt lgkmcnt(4)
    v_mfma_f32_32x32x16_bf16 v[36:51], v[12:15], v[200:203], v[36:51]
    v_exp_f32 v23, v23
    v_exp_f32 v24, v24
    v_exp_f32 v25, v25
    v_exp_f32 v26, v26
    v_exp_f32 v27, v27
    ds_read_b64_tr_b16 v[12:13], v2 offset:10240
    ds_read_b64_tr_b16 v[14:15], v2 offset:10496
    s_waitcnt lgkmcnt(4)
    v_mfma_f32_32x32x16_bf16 v[36:51], v[4:7], v[196:199], v[36:51]
    v_add_f32 v20, 1.0, v20
    v_add_f32 v21, 1.0, v21
    v_add_f32 v22, 1.0, v22
    v_add_f32 v23, 1.0, v23
    v_add_f32 v24, 1.0, v24
    v_add_f32 v25, 1.0, v25
    v_add_f32 v26, 1.0, v26
    v_add_f32 v27, 1.0, v27
    v_rcp_f32 v20, v20
    v_rcp_f32 v21, v21
    v_rcp_f32 v22, v22
    ds_read_b64_tr_b16 v[4:5], v2 offset:12288
    ds_read_b64_tr_b16 v[6:7], v2 offset:12544
    s_waitcnt lgkmcnt(4)
    v_mfma_f32_32x32x16_bf16 v[36:51], v[8:11], v[192:195], v[36:51]
    v_rcp_f32 v23, v23
    v_rcp_f32 v24, v24
    v_rcp_f32 v25, v25
    v_rcp_f32 v26, v26
    v_rcp_f32 v27, v27
    ds_read_b64_tr_b16 v[8:9], v2 offset:14336
    ds_read_b64_tr_b16 v[10:11], v2 offset:14592
    s_waitcnt lgkmcnt(4)
    v_mfma_f32_32x32x16_bf16 v[36:51], v[12:15], v[188:191], v[36:51]
    v_mul_f32 v28, v20, v28
    v_mul_f32 v29, v21, v29
    v_mul_f32 v30, v22, v30
    v_mul_f32 v31, v23, v31
    v_mul_f32 v32, v24, v32
    v_mul_f32 v33, v25, v33
    v_mul_f32 v34, v26, v34
    v_mul_f32 v35, v27, v35
    v_cvt_pk_bf16_f32 v20, v28, v29
    v_cvt_pk_bf16_f32 v21, v30, v31
    v_cvt_pk_bf16_f32 v22, v32, v33
    v_cvt_pk_bf16_f32 v23, v34, v35
    s_add_u32 s78, s79, 65536
    buffer_store_dwordx4 v[20:23], v246, s[52:55], s78 offen sc1
    s_waitcnt vmcnt(5) lgkmcnt(0)
    s_cmp_lg_u32 s60, 0
    s_cbranch_scc1 LA_back_13
    s_waitcnt vmcnt(5)
    v_readfirstlane_b32 s87, v0
    s_nop 0
    s_cmp_eq_u32 s87, 8
    s_cbranch_scc0 LA_slow_12
LA_back_13:
    s_barrier
    v_mov_b32 v3, 1
    s_cmp_lg_u32 s60, 0
    s_cbranch_scc1 LA_nosig_9
    s_mov_b64 exec, 1
    buffer_atomic_add v3, v245, s[52:55], s86 offen
    s_mov_b64 exec, -1
LA_nosig_9:
    ds_read_b64_tr_b16 v[12:13], v2 offset:16384
    ds_read_b64_tr_b16 v[14:15], v2 offset:16640
    v_mfma_f32_32x32x16_bf16 v[36:51], v[4:7], v[184:187], v[36:51]
    s_add_u32 m0, s68, 65536
    s_add_u32 s76, s27, s71
    buffer_load_dwordx4 v251, s[44:47], s76 offen lds
    v_mul_f32 v60, s75, v60
    v_mul_f32 v61, s75, v61
    v_mul_f32 v62, s75, v62
    v_mul_f32 v63, s75, v63
    v_mul_f32 v64, s75, v64
    v_mul_f32 v65, s75, v65
    v_mul_f32 v66, s75, v66
    v_mul_f32 v67, s75, v67
    v_exp_f32 v60, v60
    v_exp_f32 v61, v61
    v_exp_f32 v62, v62
    s_lshr_b32 s78, s6, 1
    s_add_u32 s78, s78, s81
    buffer_load_dwordx4 v[4:7], v246, s[52:55], s78 offen sc1
    buffer_load_dwordx4 v[16:19], v246, s[52:55], s78 offen offset:1024 sc1
    ds_read_b64_tr_b16 v[20:21], v2 offset:18432
    ds_read_b64_tr_b16 v[22:23], v2 offset:18688
    v_mfma_f32_32x32x16_bf16 v[36:51], v[8:11], v[180:183], v[36:51]
    buffer_load_dwordx4 v250, s[44:47], s76 offen offset:1024 lds
    v_exp_f32 v63, v63
    v_exp_f32 v64, v64
    v_exp_f32 v65, v65
    v_exp_f32 v66, v66
    v_exp_f32 v67, v67
    ds_read_b64_tr_b16 v[8:9], v2 offset:20480
    ds_read_b64_tr_b16 v[10:11], v2 offset:20736
    s_waitcnt lgkmcnt(4)
    v_mfma_f32_32x32x16_bf16 v[36:51], v[12:15], v[176:179], v[36:51]
    s_add_u32 m0, s68, 98304
    s_add_u32 s76, s6, s98
    buffer_load_dwordx4 v251, s[44:47], s76 offen lds
    v_add_f32 v60, 1.0, v60
    v_add_f32 v61, 1.0, v61
    v_add_f32 v62, 1.0, v62
    v_add_f32 v63, 1.0, v63
    v_add_f32 v64, 1.0, v64
    v_add_f32 v65, 1.0, v65
    v_add_f32 v66, 1.0, v66
    v_add_f32 v67, 1.0, v67
    v_rcp_f32 v60, v60
    v_rcp_f32 v61, v61
    v_rcp_f32 v62, v62
    ds_read_b64_tr_b16 v[12:13], v2 offset:22528
    ds_read_b64_tr_b16 v[14:15], v2 offset:22784
    s_waitcnt lgkmcnt(4)
    v_mfma_f32_32x32x16_bf16 v[36:51], v[20:23], v[172:175], v[36:51]
    buffer_load_dwordx4 v250, s[44:47], s76 offen offset:1024 lds
    v_rcp_f32 v63, v63
    v_rcp_f32 v64, v64
    v_rcp_f32 v65, v65
    v_rcp_f32 v66, v66
    v_rcp_f32 v67, v67
    ds_read_b64_tr_b16 v[20:21], v2 offset:24576
    ds_read_b64_tr_b16 v[22:23], v2 offset:24832
    s_waitcnt lgkmcnt(4)
    v_mfma_f32_32x32x16_bf16 v[36:51], v[8:11], v[168:171], v[36:51]
    v_mul_f32 v68, v60, v68
    v_mul_f32 v69, v61, v69
    v_mul_f32 v70, v62, v70
    v_mul_f32 v71, v63, v71
    v_mul_f32 v72, v64, v72
    v_mul_f32 v73, v65, v73
    v_mul_f32 v74, v66, v74
    v_mul_f32 v75, v67, v75
    v_cvt_pk_bf16_f32 v60, v68, v69
    v_cvt_pk_bf16_f32 v61, v70, v71
    v_cvt_pk_bf16_f32 v62, v72, v73
    v_cvt_pk_bf16_f32 v63, v74, v75
    s_add_u32 s78, s79, 73728
    buffer_store_dwordx4 v[60:63], v246, s[52:55], s78 offen sc1
    ds_read_b64_tr_b16 v[8:9], v2 offset:26624
    ds_read_b64_tr_b16 v[10:11], v2 offset:26880
    s_waitcnt lgkmcnt(4)
    v_mfma_f32_32x32x16_bf16 v[36:51], v[12:15], v[164:167], v[36:51]
    ds_read_b64_tr_b16 v[12:13], v2 offset:28672
    ds_read_b64_tr_b16 v[14:15], v2 offset:28928
    s_waitcnt lgkmcnt(4)
    v_mfma_f32_32x32x16_bf16 v[36:51], v[20:23], v[160:163], v[36:51]
    ds_read_b64_tr_b16 v[20:21], v2 offset:30720
    ds_read_b64_tr_b16 v[22:23], v2 offset:30976
    s_waitcnt lgkmcnt(4)
    v_mfma_f32_32x32x16_bf16 v[36:51], v[8:11], v[156:159], v[36:51]
    s_waitcnt lgkmcnt(0)
    s_barrier
    ds_read_b64_tr_b16 v[8:9], v1
    ds_read_b64_tr_b16 v[10:11], v1 offset:256
    v_mfma_f32_32x32x16_bf16 v[36:51], v[12:15], v[152:155], v[36:51]
    s_add_u32 m0, s68, 81920
    s_add_u32 s76, s7, s98
    buffer_load_dwordx4 v251, s[44:47], s76 offen lds
    s_lshr_b32 s78, s7, 1
    s_add_u32 s78, s78, s81
    buffer_load_dwordx4 v[12:15], v246, s[52:55], s78 offen sc1
    buffer_load_dwordx4 v[24:27], v246, s[52:55], s78 offen offset:1024 sc1
    ds_read_b64_tr_b16 v[28:29], v1 offset:2048
    ds_read_b64_tr_b16 v[30:31], v1 offset:2304
    v_mfma_f32_32x32x16_bf16 v[36:51], v[20:23], v[148:151], v[36:51]
    buffer_load_dwordx4 v250, s[44:47], s76 offen offset:1024 lds
    ds_read_b64_tr_b16 v[20:21], v1 offset:4096
    ds_read_b64_tr_b16 v[22:23], v1 offset:4352
    s_waitcnt lgkmcnt(4)
    v_mfma_f32_32x32x16_bf16 v[36:51], v[8:11], v[144:147], v[36:51]
    s_add_u32 m0, s68, 131072
    s_add_u32 s76, s26, s98
    buffer_load_dwordx4 v251, s[44:47], s76 offen lds
    ds_read_b64_tr_b16 v[8:9], v1 offset:6144
    ds_read_b64_tr_b16 v[10:11], v1 offset:6400
    s_waitcnt lgkmcnt(4)
    v_mfma_f32_32x32x16_bf16 v[36:51], v[28:31], v[140:143], v[36:51]
    buffer_load_dwordx4 v250, s[44:47], s76 offen offset:1024 lds
    ds_read_b64_tr_b16 v[28:29], v1 offset:8192
    ds_read_b64_tr_b16 v[30:31], v1 offset:8448
    s_waitcnt lgkmcnt(4)
    v_mfma_f32_32x32x16_bf16 v[36:51], v[20:23], v[136:139], v[36:51]
    ds_read_b64_tr_b16 v[20:21], v1 offset:10240
    ds_read_b64_tr_b16 v[22:23], v1 offset:10496
    s_waitcnt lgkmcnt(4)
    v_mfma_f32_32x32x16_bf16 v[36:51], v[8:11], v[132:135], v[36:51]
    ds_read_b64_tr_b16 v[8:9], v1 offset:12288
    ds_read_b64_tr_b16 v[10:11], v1 offset:12544
    s_waitcnt lgkmcnt(4)
    v_mfma_f32_32x32x16_bf16 v[36:51], v[28:31], v[124:127], v[36:51]
    ds_read_b64_tr_b16 v[28:29], v1 offset:14336
    ds_read_b64_tr_b16 v[30:31], v1 offset:14592
    s_waitcnt lgkmcnt(4)
    v_mfma_f32_32x32x16_bf16 v[36:51], v[20:23], v[116:119], v[36:51]
    s_waitcnt vmcnt(6) lgkmcnt(0)
    s_barrier
    v_mov_b32 v0, 1
    s_cmp_lg_u32 s60, 0
    s_cbranch_scc1 LA_nosig_10
    s_mov_b64 exec, 1
    buffer_atomic_add v0, v245, s[52:55], s84 offen offset:256
    s_mov_b64 exec, -1
LA_nosig_10:
    ds_read_b64_tr_b16 v[20:21], v1 offset:16384
    ds_read_b64_tr_b16 v[22:23], v1 offset:16640
    v_mfma_f32_32x32x16_bf16 v[36:51], v[8:11], v[112:115], v[36:51]
    s_add_u32 m0, s68, 147456
    s_add_u32 s76, s27, s98
    buffer_load_dwordx4 v251, s[44:47], s76 offen lds
    s_lshr_b32 s78, s26, 1
    s_add_u32 s78, s78, s81
    buffer_load_dwordx4 v[8:11], v246, s[52:55], s78 offen sc1
    buffer_load_dwordx4 v[32:35], v246, s[52:55], s78 offen offset:1024 sc1
    ds_read_b64_tr_b16 v[52:53], v1 offset:18432
    ds_read_b64_tr_b16 v[54:55], v1 offset:18688
    v_mfma_f32_32x32x16_bf16 v[36:51], v[28:31], v[108:111], v[36:51]
    buffer_load_dwordx4 v250, s[44:47], s76 offen offset:1024 lds
    ds_read_b64_tr_b16 v[28:29], v1 offset:20480
    ds_read_b64_tr_b16 v[30:31], v1 offset:20736
    s_waitcnt lgkmcnt(4)
    v_mfma_f32_32x32x16_bf16 v[36:51], v[20:23], v[104:107], v[36:51]
    s_add_u32 m0, s68, 0
    s_add_u32 s76, s6, s71
    s_add_u32 s76, s76, 65536
    buffer_load_dwordx4 v251, s[44:47], s76 offen lds
    v_bfe_u32 v0, v255, 5, 1
    v_lshlrev_b32 v2, 9, v0
    v_bfe_u32 v0, v255, 2, 2
    ds_read_b64_tr_b16 v[20:21], v1 offset:22528
    ds_read_b64_tr_b16 v[22:23], v1 offset:22784
    s_waitcnt lgkmcnt(4)
    v_mfma_f32_32x32x16_bf16 v[36:51], v[52:55], v[100:103], v[36:51]
    buffer_load_dwordx4 v250, s[44:47], s76 offen offset:1024 lds
    v_lshl_add_u32 v2, v0, 7, v2
    v_bfe_u32 v0, v255, 3, 1
    s_lshl_b32 s78, s65, 1
    s_add_u32 s78, s78, s62
    s_lshl_b32 s78, s78, 7
    s_add_u32 s78, s78, 9568256
    v_bfe_u32 v3, v255, 0, 5
    v_lshlrev_b32 v52, 2, v3
    buffer_load_dword v253, v52, s[52:55], s78 offen sc1
    ds_read_b64_tr_b16 v[52:53], v1 offset:24576
    ds_read_b64_tr_b16 v[54:55], v1 offset:24832
    s_waitcnt lgkmcnt(4)
    v_mfma_f32_32x32x16_bf16 v[36:51], v[28:31], v[96:99], v[36:51]
    v_lshl_add_u32 v2, v0, 6, v2
    v_bfe_u32 v0, v255, 4, 1
    v_lshl_add_u32 v2, v0, 5, v2
    ds_read_b64_tr_b16 v[28:29], v1 offset:26624
    ds_read_b64_tr_b16 v[30:31], v1 offset:26880
    s_waitcnt lgkmcnt(4)
    v_mfma_f32_32x32x16_bf16 v[36:51], v[20:23], v[92:95], v[36:51]
    v_bfe_u32 v0, v255, 0, 2
    v_lshl_add_u32 v2, v0, 3, v2
    ds_read_b64_tr_b16 v[20:21], v1 offset:28672
    ds_read_b64_tr_b16 v[22:23], v1 offset:28928
    s_waitcnt lgkmcnt(4)
    v_mfma_f32_32x32x16_bf16 v[36:51], v[52:55], v[88:91], v[36:51]
    s_lshl_b32 s78, s61, 12
    v_add_u32 v2, s78, v2
    v_xor_b32 v0, 64, v2
    ds_read_b64_tr_b16 v[52:53], v1 offset:30720
    ds_read_b64_tr_b16 v[54:55], v1 offset:30976
    s_waitcnt lgkmcnt(4)
    v_mfma_f32_32x32x16_bf16 v[36:51], v[28:31], v[84:87], v[36:51]
    s_waitcnt lgkmcnt(0)
    s_barrier
    ds_read_b64_tr_b16 v[28:29], v2 offset:32768
    ds_read_b64_tr_b16 v[30:31], v2 offset:33792
    v_mfma_f32_32x32x16_bf16 v[36:51], v[20:23], v[80:83], v[36:51]
    s_add_u32 m0, s68, 16384
    s_add_u32 s76, s7, s71
    s_add_u32 s76, s76, 65536
    buffer_load_dwordx4 v251, s[44:47], s76 offen lds
    s_lshr_b32 s78, s27, 1
    s_add_u32 s78, s78, s81
    buffer_load_dwordx4 v[20:23], v246, s[52:55], s78 offen sc1
    buffer_load_dwordx4 v[56:59], v246, s[52:55], s78 offen offset:1024 sc1
    ds_read_b64_tr_b16 v[60:61], v0 offset:32768
    ds_read_b64_tr_b16 v[62:63], v0 offset:33792
    v_mfma_f32_32x32x16_bf16 v[36:51], v[52:55], v[76:79], v[36:51]
    buffer_load_dwordx4 v250, s[44:47], s76 offen offset:1024 lds
    ds_read_b64_tr_b16 v[52:53], v2 offset:34816
    ds_read_b64_tr_b16 v[54:55], v2 offset:35840
    s_waitcnt lgkmcnt(4)
    v_mfma_f32_32x32x16_bf16 v[64:79], v[28:31], v[4:7], 0
    ds_read_b64_tr_b16 v[28:29], v0 offset:34816
    ds_read_b64_tr_b16 v[30:31], v0 offset:35840
    s_waitcnt lgkmcnt(4)
    v_mfma_f32_32x32x16_bf16 v[80:95], v[60:63], v[4:7], 0
    s_nop 2
    v_mul_f32 v36, s75, v36
    v_mul_f32 v37, s75, v37
    v_mul_f32 v38, s75, v38
    v_mul_f32 v39, s75, v39
    v_mul_f32 v40, s75, v40
    v_mul_f32 v41, s75, v41
    v_mul_f32 v42, s75, v42
    v_mul_f32 v43, s75, v43
    v_exp_f32 v36, v36
    v_exp_f32 v37, v37
    v_exp_f32 v38, v38
    v_exp_f32 v39, v39
    v_exp_f32 v40, v40
    v_exp_f32 v41, v41
    v_exp_f32 v42, v42
    v_exp_f32 v43, v43
    v_add_f32 v36, 1.0, v36
    v_add_f32 v37, 1.0, v37
    v_add_f32 v38, 1.0, v38
    v_add_f32 v39, 1.0, v39
    v_add_f32 v40, 1.0, v40
    v_add_f32 v41, 1.0, v41
    v_add_f32 v42, 1.0, v42
    v_add_f32 v43, 1.0, v43
    s_waitcnt lgkmcnt(0)
    s_barrier
    s_cmp_lg_u32 s60, 0
    s_cbranch_scc1 LA_np_17
    buffer_load_dword v1, v245, s[52:55], s85 offen offset:256 sc1
LA_np_17:
    ds_read_b64_tr_b16 v[4:5], v2 offset:49152
    ds_read_b64_tr_b16 v[6:7], v2 offset:50176
    v_mfma_f32_32x32x16_bf16 v[64:79], v[52:55], v[16:19], v[64:79]
    s_add_u32 m0, s68, 32768
    s_add_u32 s76, s26, s71
    s_add_u32 s76, s76, 65536
    buffer_load_dwordx4 v251, s[44:47], s76 offen lds
    v_rcp_f32 v36, v36
    v_rcp_f32 v37, v37
    v_rcp_f32 v38, v38
    v_rcp_f32 v39, v39
    v_rcp_f32 v40, v40
    v_rcp_f32 v41, v41
    v_rcp_f32 v42, v42
    v_rcp_f32 v43, v43
    v_mul_f32 v44, v36, v44
    v_mul_f32 v45, v37, v45
    v_mul_f32 v46, v38, v46
    v_mul_f32 v47, v39, v47
    v_mul_f32 v48, v40, v48
    v_mul_f32 v49, v41, v49
    v_mul_f32 v50, v42, v50
    v_mul_f32 v51, v43, v51
    v_cvt_pk_bf16_f32 v36, v44, v45
    v_cvt_pk_bf16_f32 v37, v46, v47
    v_cvt_pk_bf16_f32 v38, v48, v49
    v_cvt_pk_bf16_f32 v39, v50, v51
    s_add_u32 s78, s80, 98304
    buffer_store_dwordx4 v[36:39], v246, s[52:55], s78 offen sc1
    s_nop 1
    ds_read_b64_tr_b16 v[36:37], v0 offset:49152
    ds_read_b64_tr_b16 v[38:39], v0 offset:50176
    v_mfma_f32_32x32x16_bf16 v[80:95], v[28:31], v[16:19], v[80:95]
    buffer_load_dwordx4 v250, s[44:47], s76 offen offset:1024 lds
    ds_read_b64_tr_b16 v[16:17], v2 offset:51200
    ds_read_b64_tr_b16 v[18:19], v2 offset:52224
    s_waitcnt vmcnt(18) lgkmcnt(4)
    v_mfma_f32_32x32x16_bf16 v[64:79], v[4:7], v[12:15], v[64:79]
    ds_read_b64_tr_b16 v[4:5], v0 offset:51200
    ds_read_b64_tr_b16 v[6:7], v0 offset:52224
    s_waitcnt lgkmcnt(4)
    v_mfma_f32_32x32x16_bf16 v[80:95], v[36:39], v[12:15], v[80:95]
    s_waitcnt lgkmcnt(0)
    s_barrier
    v_add_u32 v3, 0x10000, v2
    ds_read_b64_tr_b16 v[12:13], v3 offset:49152
    ds_read_b64_tr_b16 v[14:15], v3 offset:50176
    s_waitcnt vmcnt(17)
    v_mfma_f32_32x32x16_bf16 v[64:79], v[16:19], v[24:27], v[64:79]
    s_add_u32 m0, s68, 49152
    s_add_u32 s76, s27, s71
    s_add_u32 s76, s76, 65536
    buffer_load_dwordx4 v251, s[44:47], s76 offen lds
    v_add_u32 v16, 0x10000, v0
    ds_read_b64_tr_b16 v[28:29], v16 offset:49152
    ds_read_b64_tr_b16 v[30:31], v16 offset:50176
    v_mfma_f32_32x32x16_bf16 v[80:95], v[4:7], v[24:27], v[80:95]
    buffer_load_dwordx4 v250, s[44:47], s76 offen offset:1024 lds
    ds_read_b64_tr_b16 v[4:5], v3 offset:51200
    ds_read_b64_tr_b16 v[6:7], v3 offset:52224
    s_waitcnt vmcnt(14) lgkmcnt(4)
    v_mfma_f32_32x32x16_bf16 v[64:79], v[12:15], v[8:11], v[64:79]
    ds_read_b64_tr_b16 v[12:13], v16 offset:51200
    ds_read_b64_tr_b16 v[14:15], v16 offset:52224
    s_waitcnt lgkmcnt(4)
    v_mfma_f32_32x32x16_bf16 v[80:95], v[28:31], v[8:11], v[80:95]
    s_waitcnt lgkmcnt(0)
    s_cmp_lg_u32 s60, 0
    s_cbranch_scc1 LA_back_16
    s_waitcnt vmcnt(5)
    v_readfirstlane_b32 s87, v1
    s_nop 0
    s_cmp_eq_u32 s87, 8
    s_cbranch_scc0 LA_slow_15
LA_back_16:
    s_barrier
    ds_read_b64_tr_b16 v[8:9], v3
    ds_read_b64_tr_b16 v[10:11], v3 offset:1024
    s_waitcnt vmcnt(13)
    v_mfma_f32_32x32x16_bf16 v[64:79], v[4:7], v[32:35], v[64:79]
    s_add_u32 m0, s68, 114688
    s_add_u32 s76, s3, 0
    s_and_b32 s76, s76, 1
    s_mul_i32 s76, s76, 16384
    s_add_u32 s76, s76, s73
    buffer_load_dwordx4 v251, s[44:47], s76 offen lds
    s_lshr_b32 s78, s6, 1
    s_add_u32 s78, s78, s81
    s_add_u32 s78, s78, 65536
    buffer_load_dwordx4 v[4:7], v246, s[52:55], s78 offen sc1
    buffer_load_dwordx4 v[24:27], v246, s[52:55], s78 offen offset:1024 sc1
    ds_read_b64_tr_b16 v[28:29], v16
    ds_read_b64_tr_b16 v[30:31], v16 offset:1024
    v_mfma_f32_32x32x16_bf16 v[80:95], v[12:15], v[32:35], v[80:95]
    buffer_load_dwordx4 v250, s[44:47], s76 offen offset:1024 lds
    ds_read_b64_tr_b16 v[12:13], v3 offset:2048
    ds_read_b64_tr_b16 v[14:15], v3 offset:3072
    s_waitcnt vmcnt(11) lgkmcnt(4)
    v_mfma_f32_32x32x16_bf16 v[64:79], v[8:11], v[20:23], v[64:79]
    ds_read_b64_tr_b16 v[8:9], v16 offset:2048
    ds_read_b64_tr_b16 v[10:11], v16 offset:3072
    s_waitcnt lgkmcnt(4)
    v_mfma_f32_32x32x16_bf16 v[80:95], v[28:31], v[20:23], v[80:95]
    s_lshr_b32 s78, s7, 1
    s_add_u32 s78, s78, s81
    s_add_u32 s78, s78, 65536
    buffer_load_dwordx4 v[20:23], v246, s[52:55], s78 offen sc1
    buffer_load_dwordx4 v[28:31], v246, s[52:55], s78 offen offset:1024 sc1
    s_waitcnt vmcnt(9) lgkmcnt(0)
    s_barrier
    v_mov_b32 v17, 1
    s_cmp_lg_u32 s60, 0
    s_cbranch_scc1 LA_nosig_11
    s_mov_b64 exec, 1
    buffer_atomic_add v17, v245, s[52:55], s84 offen offset:512
    s_mov_b64 exec, -1
LA_nosig_11:
    ds_read_b64_tr_b16 v[32:33], v3 offset:32768
    ds_read_b64_tr_b16 v[34:35], v3 offset:33792
    v_mfma_f32_32x32x16_bf16 v[64:79], v[12:15], v[56:59], v[64:79]
    s_add_u32 m0, s68, 65536
    s_add_u32 s76, s3, 1
    s_and_b32 s76, s76, 1
    s_mul_i32 s76, s76, 16384
    s_add_u32 s76, s76, s73
    buffer_load_dwordx4 v251, s[44:47], s76 offen lds
    ds_read_b64_tr_b16 v[12:13], v16 offset:32768
    ds_read_b64_tr_b16 v[14:15], v16 offset:33792
    v_mfma_f32_32x32x16_bf16 v[80:95], v[8:11], v[56:59], v[80:95]
    buffer_load_dwordx4 v250, s[44:47], s76 offen offset:1024 lds
    ds_read_b64_tr_b16 v[8:9], v3 offset:34816
    ds_read_b64_tr_b16 v[10:11], v3 offset:35840
    s_waitcnt vmcnt(6) lgkmcnt(4)
    v_mfma_f32_32x32x16_bf16 v[64:79], v[32:35], v[4:7], v[64:79]
    s_lshr_b32 s78, s26, 1
    s_add_u32 s78, s78, s81
    s_add_u32 s78, s78, 65536
    buffer_load_dwordx4 v[32:35], v246, s[52:55], s78 offen sc1
    buffer_load_dwordx4 v[36:39], v246, s[52:55], s78 offen offset:1024 sc1
    ds_read_b64_tr_b16 v[40:41], v16 offset:34816
    ds_read_b64_tr_b16 v[42:43], v16 offset:35840
    s_waitcnt lgkmcnt(4)
    v_mfma_f32_32x32x16_bf16 v[80:95], v[12:15], v[4:7], v[80:95]
    s_waitcnt lgkmcnt(0)
    s_barrier
    ds_read_b64_tr_b16 v[4:5], v3 offset:16384
    ds_read_b64_tr_b16 v[6:7], v3 offset:17408
    s_waitcnt vmcnt(7)
    v_mfma_f32_32x32x16_bf16 v[64:79], v[8:11], v[24:27], v[64:79]
    s_add_u32 m0, s68, 98304
    s_add_u32 s76, s6, s72
    buffer_load_dwordx4 v251, s[48:51], s76 offen lds
    ds_read_b64_tr_b16 v[8:9], v16 offset:16384
    ds_read_b64_tr_b16 v[10:11], v16 offset:17408
    v_mfma_f32_32x32x16_bf16 v[80:95], v[40:43], v[24:27], v[80:95]
    buffer_load_dwordx4 v250, s[48:51], s76 offen offset:1024 lds
    s_lshr_b32 s78, s27, 1
    s_add_u32 s78, s78, s81
    s_add_u32 s78, s78, 65536
    buffer_load_dwordx4 v[12:15], v246, s[52:55], s78 offen sc1
    buffer_load_dwordx4 v[24:27], v246, s[52:55], s78 offen offset:1024 sc1
    ds_read_b64_tr_b16 v[40:41], v3 offset:18432
    ds_read_b64_tr_b16 v[42:43], v3 offset:19456
    s_waitcnt vmcnt(9) lgkmcnt(4)
    v_mfma_f32_32x32x16_bf16 v[64:79], v[4:7], v[20:23], v[64:79]
    ds_read_b64_tr_b16 v[4:5], v16 offset:18432
    ds_read_b64_tr_b16 v[6:7], v16 offset:19456
    s_waitcnt lgkmcnt(4)
    v_mfma_f32_32x32x16_bf16 v[80:95], v[8:11], v[20:23], v[80:95]
    s_waitcnt lgkmcnt(0)
    s_barrier
    s_cmp_lg_u32 s60, 0
    s_cbranch_scc1 LA_np_23
    buffer_load_dword v1, v245, s[52:55], s85 offen offset:512 sc1
LA_np_23:
    v_add_u32 v8, 0x20000, v2
    ds_read_b64_tr_b16 v[20:21], v8
    ds_read_b64_tr_b16 v[22:23], v8 offset:1024
    s_waitcnt vmcnt(8)
    v_mfma_f32_32x32x16_bf16 v[64:79], v[40:43], v[28:31], v[64:79]
    s_add_u32 m0, s68, 81920
    s_add_u32 s76, s7, s72
    buffer_load_dwordx4 v251, s[48:51], s76 offen lds
    v_add_u32 v9, 0x20000, v0
    ds_read_b64_tr_b16 v[40:41], v9
    ds_read_b64_tr_b16 v[42:43], v9 offset:1024
    v_mfma_f32_32x32x16_bf16 v[80:95], v[4:7], v[28:31], v[80:95]
    buffer_load_dwordx4 v250, s[48:51], s76 offen offset:1024 lds
    ds_read_b64_tr_b16 v[4:5], v8 offset:2048
    ds_read_b64_tr_b16 v[6:7], v8 offset:3072
    s_waitcnt vmcnt(7) lgkmcnt(4)
    v_mfma_f32_32x32x16_bf16 v[64:79], v[20:23], v[32:35], v[64:79]
    ds_read_b64_tr_b16 v[20:21], v9 offset:2048
    ds_read_b64_tr_b16 v[22:23], v9 offset:3072
    s_waitcnt lgkmcnt(4)
    v_mfma_f32_32x32x16_bf16 v[80:95], v[40:43], v[32:35], v[80:95]
    s_waitcnt lgkmcnt(0)
    s_cmp_lg_u32 s60, 0
    s_cbranch_scc1 LA_back_22
    s_waitcnt vmcnt(2)
    v_readfirstlane_b32 s87, v1
    s_nop 0
    s_cmp_eq_u32 s87, 16
    s_cbranch_scc0 LA_slow_21
LA_back_22:
    s_barrier
    ds_read_b64_tr_b16 v[28:29], v8 offset:16384
    ds_read_b64_tr_b16 v[30:31], v8 offset:17408
    s_waitcnt vmcnt(6)
    v_mfma_f32_32x32x16_bf16 v[64:79], v[4:7], v[36:39], v[64:79]
    s_add_u32 m0, s68, 131072
    s_add_u32 s76, s26, s72
    buffer_load_dwordx4 v251, s[48:51], s76 offen lds
    s_lshr_b32 s78, s6, 1
    s_add_u32 s78, s78, s81
    s_add_u32 s78, s78, 32768
    buffer_load_dwordx4 v[4:7], v246, s[52:55], s78 offen sc1
    buffer_load_dwordx4 v[32:35], v246, s[52:55], s78 offen offset:1024 sc1
    ds_read_b64_tr_b16 v[40:41], v9 offset:16384
    ds_read_b64_tr_b16 v[42:43], v9 offset:17408
    v_mfma_f32_32x32x16_bf16 v[80:95], v[20:23], v[36:39], v[80:95]
    buffer_load_dwordx4 v250, s[48:51], s76 offen offset:1024 lds
    ds_read_b64_tr_b16 v[20:21], v8 offset:18432
    ds_read_b64_tr_b16 v[22:23], v8 offset:19456
    s_waitcnt vmcnt(7) lgkmcnt(4)
    v_mfma_f32_32x32x16_bf16 v[64:79], v[28:31], v[12:15], v[64:79]
    ds_read_b64_tr_b16 v[28:29], v9 offset:18432
    ds_read_b64_tr_b16 v[30:31], v9 offset:19456
    s_waitcnt lgkmcnt(4)
    v_mfma_f32_32x32x16_bf16 v[80:95], v[40:43], v[12:15], v[80:95]
    s_lshr_b32 s78, s7, 1
    s_add_u32 s78, s78, s81
    s_add_u32 s78, s78, 32768
    buffer_load_dwordx4 v[12:15], v246, s[52:55], s78 offen sc1
    buffer_load_dwordx4 v[36:39], v246, s[52:55], s78 offen offset:1024 sc1
    s_waitcnt lgkmcnt(0)
    s_barrier
    ds_read_b64_tr_b16 v[40:41], v2
    ds_read_b64_tr_b16 v[42:43], v2 offset:1024
    s_waitcnt vmcnt(8)
    v_mfma_f32_32x32x16_bf16 v[64:79], v[20:23], v[24:27], v[64:79]
    s_add_u32 m0, s68, 147456
    s_add_u32 s76, s27, s72
    buffer_load_dwordx4 v251, s[48:51], s76 offen lds
    ds_read_b64_tr_b16 v[20:21], v0
    ds_read_b64_tr_b16 v[22:23], v0 offset:1024
    v_mfma_f32_32x32x16_bf16 v[80:95], v[28:31], v[24:27], v[80:95]
    buffer_load_dwordx4 v250, s[48:51], s76 offen offset:1024 lds
    ds_read_b64_tr_b16 v[24:25], v2 offset:2048
    ds_read_b64_tr_b16 v[26:27], v2 offset:3072
    s_waitcnt vmcnt(6) lgkmcnt(4)
    v_mfma_f32_32x32x16_bf16 v[64:79], v[40:43], v[4:7], v[64:79]
    s_lshr_b32 s78, s26, 1
    s_add_u32 s78, s78, s81
    s_add_u32 s78, s78, 32768
    buffer_load_dwordx4 v[28:31], v246, s[52:55], s78 offen sc1
    buffer_load_dwordx4 v[40:43], v246, s[52:55], s78 offen offset:1024 sc1
    ds_read_b64_tr_b16 v[44:45], v0 offset:2048
    ds_read_b64_tr_b16 v[46:47], v0 offset:3072
    s_waitcnt lgkmcnt(4)
    v_mfma_f32_32x32x16_bf16 v[80:95], v[20:23], v[4:7], v[80:95]
    s_waitcnt lgkmcnt(0)
    s_barrier
    ds_read_b64_tr_b16 v[4:5], v2 offset:16384
    ds_read_b64_tr_b16 v[6:7], v2 offset:17408
    s_waitcnt vmcnt(7)
    v_mfma_f32_32x32x16_bf16 v[64:79], v[24:27], v[32:35], v[64:79]
    ds_read_b64_tr_b16 v[20:21], v0 offset:16384
    ds_read_b64_tr_b16 v[22:23], v0 offset:17408
    v_mfma_f32_32x32x16_bf16 v[80:95], v[44:47], v[32:35], v[80:95]
    s_lshr_b32 s78, s27, 1
    s_add_u32 s78, s78, s81
    s_add_u32 s78, s78, 32768
    buffer_load_dwordx4 v[24:27], v246, s[52:55], s78 offen sc1
    buffer_load_dwordx4 v[32:35], v246, s[52:55], s78 offen offset:1024 sc1
    ds_read_b64_tr_b16 v[44:45], v2 offset:18432
    ds_read_b64_tr_b16 v[46:47], v2 offset:19456
    s_waitcnt vmcnt(7) lgkmcnt(4)
    v_mfma_f32_32x32x16_bf16 v[64:79], v[4:7], v[12:15], v[64:79]
    s_lshr_b32 s78, s60, 1
    s_lshl_b32 s78, s78, 3
    s_lshr_b32 s78, 50462976, s78
    s_and_b32 s78, s78, 15
    s_lshl_b32 s78, s78, 1
    s_and_b32 s89, s60, 1
    s_add_u32 s78, s78, s89
    s_lshl_b32 s78, s78, 13
    v_bfe_u32 v1, v255, 0, 5
    v_lshl_add_u32 v4, v1, 8, s78
    v_bfe_u32 v1, v255, 0, 3
    v_lshl_add_u32 v4, v1, 4, v4
    v_lshrrev_b32 v1, 5, v255
    v_lshlrev_b32 v1, 4, v1
    v_xor_b32 v4, v1, v4
    v_xor_b32 v5, 32, v4
    v_xor_b32 v6, 64, v4
    v_xor_b32 v7, 0x60, v4
    ds_read_b64_tr_b16 v[48:49], v0 offset:18432
    ds_read_b64_tr_b16 v[50:51], v0 offset:19456
    s_waitcnt lgkmcnt(4)
    v_mfma_f32_32x32x16_bf16 v[80:95], v[20:23], v[12:15], v[80:95]
    s_waitcnt lgkmcnt(0)
    s_barrier
    s_cmp_lg_u32 s60, 0
    s_cbranch_scc1 LA_np_20
    buffer_load_dword v10, v245, s[52:55], s85 offen offset:768 sc1
LA_np_20:
    ds_read_b64_tr_b16 v[12:13], v2 offset:32768
    ds_read_b64_tr_b16 v[14:15], v2 offset:33792
    s_waitcnt vmcnt(6)
    v_mfma_f32_32x32x16_bf16 v[64:79], v[44:47], v[36:39], v[64:79]
    s_add_u32 s78, s3, 0
    s_and_b32 s78, s78, 1
    s_mul_i32 s78, s78, 8192
    s_add_u32 s78, s78, 98304
    s_add_u32 s78, s78, s81
    buffer_load_dwordx4 v[20:23], v246, s[52:55], s78 offen sc1
    buffer_load_dwordx4 v[44:47], v246, s[52:55], s78 offen offset:1024 sc1
    ds_read_b64_tr_b16 v[52:53], v0 offset:32768
    ds_read_b64_tr_b16 v[54:55], v0 offset:33792
    v_mfma_f32_32x32x16_bf16 v[80:95], v[48:51], v[36:39], v[80:95]
    ds_read_b64_tr_b16 v[36:37], v2 offset:34816
    ds_read_b64_tr_b16 v[38:39], v2 offset:35840
    s_waitcnt vmcnt(5) lgkmcnt(4)
    v_mfma_f32_32x32x16_bf16 v[64:79], v[12:15], v[28:31], v[64:79]
    v_bfe_u32 v11, v255, 3, 3
    v_lshlrev_b32 v12, 8, v11
    v_bfe_u32 v11, v255, 0, 3
    v_lshl_add_u32 v12, v11, 5, v12
    v_bfe_u32 v1, v255, 3, 3
    v_lshlrev_b32 v1, 4, v1
    v_xor_b32 v12, v1, v12
    ds_read_b64_tr_b16 v[48:49], v0 offset:34816
    ds_read_b64_tr_b16 v[50:51], v0 offset:35840
    s_waitcnt lgkmcnt(4)
    v_mfma_f32_32x32x16_bf16 v[80:95], v[52:55], v[28:31], v[80:95]
    s_add_u32 s78, s3, 1
    s_and_b32 s78, s78, 1
    s_mul_i32 s78, s78, 8192
    s_add_u32 s78, s78, 98304
    s_add_u32 s78, s78, s81
    buffer_load_dwordx4 v[28:31], v246, s[52:55], s78 offen sc1
    buffer_load_dwordx4 v[52:55], v246, s[52:55], s78 offen offset:1024 sc1
    s_lshl_b32 s78, s62, 4
    s_lshr_b32 s78, 50462976, s78
    s_bfe_u32 s89, s78, 0x40008
    s_and_b32 s78, s78, 15
    s_lshl_b32 s88, s61, 11
    s_lshl_b32 s89, s89, 14
    s_add_u32 s89, s89, s88
    v_add_u32 v1, s89, v12
    s_lshl_b32 s78, s78, 14
    s_add_u32 s78, s78, s88
    v_add_u32 v12, s78, v12
    ds_read_b64_tr_b16 v[56:57], v2 offset:49152
    ds_read_b64_tr_b16 v[58:59], v2 offset:50176
    s_waitcnt vmcnt(6) lgkmcnt(4)
    v_mfma_f32_32x32x16_bf16 v[64:79], v[36:39], v[40:43], v[64:79]
    s_lshl_b32 s78, s60, 13
    v_bfe_u32 v11, v255, 3, 3
    v_lshl_add_u32 v13, v11, 10, s78
    v_bfe_u32 v11, v255, 0, 3
    v_lshl_add_u32 v13, v11, 4, v13
    ds_read_b64_tr_b16 v[36:37], v0 offset:49152
    ds_read_b64_tr_b16 v[38:39], v0 offset:50176
    s_waitcnt lgkmcnt(4)
    v_mfma_f32_32x32x16_bf16 v[80:95], v[48:51], v[40:43], v[80:95]
    v_xor_b32 v11, 16, v12
    v_xor_b32 v14, 16, v1
    ds_read_b64_tr_b16 v[40:41], v2 offset:51200
    ds_read_b64_tr_b16 v[42:43], v2 offset:52224
    s_waitcnt vmcnt(5) lgkmcnt(4)
    v_mfma_f32_32x32x16_bf16 v[64:79], v[56:59], v[24:27], v[64:79]
    ds_read_b64_tr_b16 v[48:49], v0 offset:51200
    ds_read_b64_tr_b16 v[50:51], v0 offset:52224
    s_waitcnt lgkmcnt(4)
    v_mfma_f32_32x32x16_bf16 v[80:95], v[36:39], v[24:27], v[80:95]
    s_waitcnt lgkmcnt(0)
    s_cmp_lg_u32 s60, 0
    s_cbranch_scc1 LA_back_19
    s_waitcnt vmcnt(4)
    v_readfirstlane_b32 s87, v10
    s_nop 0
    s_cmp_eq_u32 s87, 8
    s_cbranch_scc0 LA_slow_18
LA_back_19:
    s_barrier
    ds_read_b64_tr_b16 v[24:25], v3 offset:49152
    ds_read_b64_tr_b16 v[26:27], v3 offset:50176
    s_waitcnt vmcnt(4)
    v_mfma_f32_32x32x16_bf16 v[64:79], v[40:43], v[32:35], v[64:79]
    s_lshr_b32 s78, s6, 1
    s_add_u32 s78, s78, s81
    s_add_u32 s78, s78, 114688
    buffer_load_dwordx4 v[36:39], v246, s[52:55], s78 offen sc1
    buffer_load_dwordx4 v[40:43], v246, s[52:55], s78 offen offset:1024 sc1
    ds_read_b64_tr_b16 v[56:57], v16 offset:49152
    ds_read_b64_tr_b16 v[58:59], v16 offset:50176
    v_mfma_f32_32x32x16_bf16 v[80:95], v[48:51], v[32:35], v[80:95]
    ds_read_b64_tr_b16 v[32:33], v3 offset:51200
    ds_read_b64_tr_b16 v[34:35], v3 offset:52224
    s_waitcnt vmcnt(5) lgkmcnt(4)
    v_mfma_f32_32x32x16_bf16 v[64:79], v[24:27], v[20:23], v[64:79]
    s_lshr_b32 s78, s7, 1
    s_add_u32 s78, s78, s81
    s_add_u32 s78, s78, 114688
    buffer_load_dwordx4 v[24:27], v246, s[52:55], s78 offen sc1
    buffer_load_dwordx4 v[48:51], v246, s[52:55], s78 offen offset:1024 sc1
    ds_read_b64_tr_b16 v[60:61], v16 offset:51200
    ds_read_b64_tr_b16 v[62:63], v16 offset:52224
    s_waitcnt lgkmcnt(4)
    v_mfma_f32_32x32x16_bf16 v[80:95], v[56:59], v[20:23], v[80:95]
    ds_read_b64_tr_b16 v[20:21], v3
    ds_read_b64_tr_b16 v[22:23], v3 offset:1024
    s_waitcnt vmcnt(6) lgkmcnt(4)
    v_mfma_f32_32x32x16_bf16 v[64:79], v[32:35], v[44:47], v[64:79]
    s_lshr_b32 s78, s26, 1
    s_add_u32 s78, s78, s81
    s_add_u32 s78, s78, 114688
    buffer_load_dwordx4 v[32:35], v246, s[52:55], s78 offen sc1
    buffer_load_dwordx4 v[56:59], v246, s[52:55], s78 offen offset:1024 sc1
    ds_read_b64_tr_b16 v[96:97], v16
    ds_read_b64_tr_b16 v[98:99], v16 offset:1024
    s_waitcnt lgkmcnt(4)
    v_mfma_f32_32x32x16_bf16 v[80:95], v[60:63], v[44:47], v[80:95]
    ds_read_b64_tr_b16 v[44:45], v3 offset:2048
    ds_read_b64_tr_b16 v[46:47], v3 offset:3072
    s_waitcnt vmcnt(7) lgkmcnt(4)
    v_mfma_f32_32x32x16_bf16 v[64:79], v[20:23], v[28:31], v[64:79]
    s_lshr_b32 s78, s27, 1
    s_add_u32 s78, s78, s81
    s_add_u32 s78, s78, 114688
    buffer_load_dwordx4 v[20:23], v246, s[52:55], s78 offen sc1
    buffer_load_dwordx4 v[60:63], v246, s[52:55], s78 offen offset:1024 sc1
    ds_read_b64_tr_b16 v[100:101], v16 offset:2048
    ds_read_b64_tr_b16 v[102:103], v16 offset:3072
    s_waitcnt lgkmcnt(4)
    v_mfma_f32_32x32x16_bf16 v[80:95], v[96:99], v[28:31], v[80:95]
    ds_read_b64_tr_b16 v[28:29], v3 offset:32768
    ds_read_b64_tr_b16 v[30:31], v3 offset:33792
    s_waitcnt vmcnt(8) lgkmcnt(4)
    v_mfma_f32_32x32x16_bf16 v[64:79], v[44:47], v[52:55], v[64:79]
    ds_read_b64_tr_b16 v[44:45], v16 offset:32768
    ds_read_b64_tr_b16 v[46:47], v16 offset:33792
    s_waitcnt lgkmcnt(4)
    v_mfma_f32_32x32x16_bf16 v[80:95], v[100:103], v[52:55], v[80:95]
    ds_read_b64_tr_b16 v[52:53], v3 offset:34816
    ds_read_b64_tr_b16 v[54:55], v3 offset:35840
    s_waitcnt vmcnt(7) lgkmcnt(4)
    v_mfma_f32_32x32x16_bf16 v[96:111], v[28:31], v[36:39], 0
    ds_read_b64_tr_b16 v[28:29], v16 offset:34816
    ds_read_b64_tr_b16 v[30:31], v16 offset:35840
    s_waitcnt lgkmcnt(4)
    v_mfma_f32_32x32x16_bf16 v[112:127], v[44:47], v[36:39], 0
    ds_read_b64_tr_b16 v[36:37], v3 offset:16384
    ds_read_b64_tr_b16 v[38:39], v3 offset:17408
    s_waitcnt vmcnt(6) lgkmcnt(4)
    v_mfma_f32_32x32x16_bf16 v[96:111], v[52:55], v[40:43], v[96:111]
    ds_read_b64_tr_b16 v[44:45], v16 offset:16384
    ds_read_b64_tr_b16 v[46:47], v16 offset:17408
    s_waitcnt lgkmcnt(4)
    v_mfma_f32_32x32x16_bf16 v[112:127], v[28:31], v[40:43], v[112:127]
    ds_read_b64_tr_b16 v[28:29], v3 offset:18432
    ds_read_b64_tr_b16 v[30:31], v3 offset:19456
    s_waitcnt vmcnt(5) lgkmcnt(4)
    v_mfma_f32_32x32x16_bf16 v[96:111], v[36:39], v[24:27], v[96:111]
    v_sub_f32 v0, 1.0, v253
    v_mul_f32 v64, v0, v64
    v_mul_f32 v65, v0, v65
    v_mul_f32 v66, v0, v66
    v_mul_f32 v67, v0, v67
    ds_read_b64_tr_b16 v[36:37], v16 offset:18432
    ds_read_b64_tr_b16 v[38:39], v16 offset:19456
    s_waitcnt lgkmcnt(4)
    v_mfma_f32_32x32x16_bf16 v[112:127], v[44:47], v[24:27], v[112:127]
    v_mul_f32 v68, v0, v68
    v_mul_f32 v69, v0, v69
    v_mul_f32 v70, v0, v70
    v_mul_f32 v71, v0, v71
    ds_read_b64_tr_b16 v[16:17], v8
    ds_read_b64_tr_b16 v[18:19], v8 offset:1024
    s_waitcnt vmcnt(4) lgkmcnt(4)
    v_mfma_f32_32x32x16_bf16 v[96:111], v[28:31], v[48:51], v[96:111]
    v_mul_f32 v72, v0, v72
    v_mul_f32 v73, v0, v73
    v_mul_f32 v74, v0, v74
    v_mul_f32 v75, v0, v75
    ds_read_b64_tr_b16 v[24:25], v9
    ds_read_b64_tr_b16 v[26:27], v9 offset:1024
    s_waitcnt lgkmcnt(4)
    v_mfma_f32_32x32x16_bf16 v[112:127], v[36:39], v[48:51], v[112:127]
    v_mul_f32 v76, v0, v76
    v_mul_f32 v77, v0, v77
    v_mul_f32 v78, v0, v78
    v_mul_f32 v79, v0, v79
    ds_read_b64_tr_b16 v[28:29], v8 offset:2048
    ds_read_b64_tr_b16 v[30:31], v8 offset:3072
    s_waitcnt vmcnt(3) lgkmcnt(4)
    v_mfma_f32_32x32x16_bf16 v[96:111], v[16:19], v[32:35], v[96:111]
    v_mul_f32 v80, v0, v80
    v_mul_f32 v81, v0, v81
    v_mul_f32 v82, v0, v82
    v_mul_f32 v83, v0, v83
    ds_read_b64_tr_b16 v[16:17], v9 offset:2048
    ds_read_b64_tr_b16 v[18:19], v9 offset:3072
    s_waitcnt lgkmcnt(4)
    v_mfma_f32_32x32x16_bf16 v[112:127], v[24:27], v[32:35], v[112:127]
    v_mul_f32 v84, v0, v84
    v_mul_f32 v85, v0, v85
    v_mul_f32 v86, v0, v86
    v_mul_f32 v87, v0, v87
    ds_read_b64_tr_b16 v[24:25], v8 offset:16384
    ds_read_b64_tr_b16 v[26:27], v8 offset:17408
    s_waitcnt vmcnt(2) lgkmcnt(4)
    v_mfma_f32_32x32x16_bf16 v[96:111], v[28:31], v[56:59], v[96:111]
    v_mul_f32 v88, v0, v88
    v_mul_f32 v89, v0, v89
    v_mul_f32 v90, v0, v90
    v_mul_f32 v91, v0, v91
    ds_read_b64_tr_b16 v[28:29], v8 offset:18432
    ds_read_b64_tr_b16 v[30:31], v8 offset:19456
    s_waitcnt lgkmcnt(4)
    v_mfma_f32_32x32x16_bf16 v[112:127], v[16:19], v[56:59], v[112:127]
    v_mul_f32 v92, v0, v92
    v_mul_f32 v93, v0, v93
    v_mul_f32 v94, v0, v94
    v_mul_f32 v95, v0, v95
    ds_read_b64_tr_b16 v[16:17], v9 offset:16384
    ds_read_b64_tr_b16 v[18:19], v9 offset:17408
    s_waitcnt vmcnt(1) lgkmcnt(4)
    v_mfma_f32_32x32x16_bf16 v[96:111], v[24:27], v[20:23], v[96:111]
    ds_read_b64_tr_b16 v[24:25], v9 offset:18432
    ds_read_b64_tr_b16 v[26:27], v9 offset:19456
    s_waitcnt vmcnt(0) lgkmcnt(4)
    v_mfma_f32_32x32x16_bf16 v[96:111], v[28:31], v[60:63], v[96:111]
    s_waitcnt lgkmcnt(2)
    v_mfma_f32_32x32x16_bf16 v[112:127], v[16:19], v[20:23], v[112:127]
    s_waitcnt lgkmcnt(0)
    v_mfma_f32_32x32x16_bf16 v[112:127], v[24:27], v[60:63], v[112:127]
    s_nop 7
    v_fmac_f32 v64, v253, v96
    v_fmac_f32 v65, v253, v97
    v_fmac_f32 v66, v253, v98
    v_fmac_f32 v67, v253, v99
    ds_write_b128 v4, v[64:67]
    v_fmac_f32 v68, v253, v100
    v_fmac_f32 v69, v253, v101
    v_fmac_f32 v70, v253, v102
    v_fmac_f32 v71, v253, v103
    ds_write_b128 v5, v[68:71]
    v_fmac_f32 v72, v253, v104
    v_fmac_f32 v73, v253, v105
    v_fmac_f32 v74, v253, v106
    v_fmac_f32 v75, v253, v107
    ds_write_b128 v6, v[72:75]
    v_fmac_f32 v76, v253, v108
    v_fmac_f32 v77, v253, v109
    v_fmac_f32 v78, v253, v110
    v_fmac_f32 v79, v253, v111
    ds_write_b128 v7, v[76:79]
    v_fmac_f32 v80, v253, v112
    v_fmac_f32 v81, v253, v113
    v_fmac_f32 v82, v253, v114
    v_fmac_f32 v83, v253, v115
    ds_write_b128 v4, v[80:83] offset:128
    v_fmac_f32 v84, v253, v116
    v_fmac_f32 v85, v253, v117
    v_fmac_f32 v86, v253, v118
    v_fmac_f32 v87, v253, v119
    ds_write_b128 v5, v[84:87] offset:128
    v_fmac_f32 v88, v253, v120
    v_fmac_f32 v89, v253, v121
    v_fmac_f32 v90, v253, v122
    v_fmac_f32 v91, v253, v123
    ds_write_b128 v6, v[88:91] offset:128
    v_fmac_f32 v92, v253, v124
    v_fmac_f32 v93, v253, v125
    v_fmac_f32 v94, v253, v126
    v_fmac_f32 v95, v253, v127
    ds_write_b128 v7, v[92:95] offset:128
    s_waitcnt lgkmcnt(0)
    s_barrier
    ds_read_b128 v[4:7], v12
    ds_read_b128 v[16:19], v11
    ds_read_b128 v[20:23], v12 offset:8192
    ds_read_b128 v[24:27], v11 offset:8192
    ds_read_b128 v[8:11], v1
    ds_read_b128 v[28:31], v14
    ds_read_b128 v[32:35], v1 offset:8192
    ds_read_b128 v[0:3], v14 offset:8192
    s_waitcnt lgkmcnt(5)
    v_add_f32 v4, v4, v20
    v_add_f32 v5, v5, v21
    v_add_f32 v6, v6, v22
    v_add_f32 v7, v7, v23
    s_waitcnt lgkmcnt(4)
    v_add_f32 v16, v16, v24
    v_add_f32 v17, v17, v25
    v_add_f32 v18, v18, v26
    v_add_f32 v19, v19, v27
    s_waitcnt lgkmcnt(1)
    v_add_f32 v8, v8, v32
    v_add_f32 v9, v9, v33
    v_add_f32 v10, v10, v34
    v_add_f32 v11, v11, v35
    s_waitcnt lgkmcnt(0)
    v_add_f32 v28, v28, v0
    v_add_f32 v29, v29, v1
    v_add_f32 v30, v30, v2
    v_add_f32 v31, v31, v3
    v_add_f32 v4, v4, v8
    v_add_f32 v5, v5, v9
    v_add_f32 v6, v6, v10
    v_add_f32 v7, v7, v11
    v_add_f32 v16, v16, v28
    v_add_f32 v17, v17, v29
    v_add_f32 v18, v18, v30
    v_add_f32 v19, v19, v31
    v_cvt_pk_bf16_f32 v0, v4, v5
    v_cvt_pk_bf16_f32 v1, v6, v7
    v_cvt_pk_bf16_f32 v2, v16, v17
    v_cvt_pk_bf16_f32 v3, v18, v19
    buffer_store_dwordx4 v[0:3], v13, s[56:59], 0 offen sc1
    s_endpgm
LA_slow_6:
    s_mov_b32 s92, 4194304
LA_slow_6_l:
    global_load_dword v7, v12, s[24:25] sc1
    s_waitcnt vmcnt(0)
    v_cmp_ne_u32 vcc, 0, v7
    s_nop 1
    s_cmp_eq_u64 vcc, -1
    s_cbranch_scc1 LA_back_7
    s_sleep 6
    s_sub_u32 s92, s92, 1
    s_cmp_lg_u32 s92, 0
    s_cbranch_scc1 LA_slow_6_l
    s_branch LA_back_7
LA_slow_12:
    s_mov_b32 s92, 4194304
LA_slow_12_l:
    buffer_load_dword v0, v245, s[52:55], s85 offen sc1
    s_waitcnt vmcnt(0)
    v_readfirstlane_b32 s87, v0
    s_nop 1
    s_cmp_eq_u32 s87, 8
    s_cbranch_scc1 LA_back_13
    s_sleep 6
    s_sub_u32 s92, s92, 1
    s_cmp_lg_u32 s92, 0
    s_cbranch_scc1 LA_slow_12_l
    s_branch LA_back_13
LA_slow_15:
    s_mov_b32 s92, 4194304
LA_slow_15_l:
    buffer_load_dword v1, v245, s[52:55], s85 offen offset:256 sc1
    s_waitcnt vmcnt(0)
    v_readfirstlane_b32 s87, v1
    s_nop 1
    s_cmp_eq_u32 s87, 8
    s_cbranch_scc1 LA_back_16
    s_sleep 6
    s_sub_u32 s92, s92, 1
    s_cmp_lg_u32 s92, 0
    s_cbranch_scc1 LA_slow_15_l
    s_branch LA_back_16
LA_slow_18:
    s_mov_b32 s92, 4194304
LA_slow_18_l:
    buffer_load_dword v10, v245, s[52:55], s85 offen offset:768 sc1
    s_waitcnt vmcnt(0)
    v_readfirstlane_b32 s87, v10
    s_nop 1
    s_cmp_eq_u32 s87, 8
    s_cbranch_scc1 LA_back_19
    s_sleep 6
    s_sub_u32 s92, s92, 1
    s_cmp_lg_u32 s92, 0
    s_cbranch_scc1 LA_slow_18_l
    s_branch LA_back_19
LA_slow_21:
    s_mov_b32 s92, 4194304
LA_slow_21_l:
    buffer_load_dword v1, v245, s[52:55], s85 offen offset:512 sc1
    s_waitcnt vmcnt(0)
    v_readfirstlane_b32 s87, v1
    s_nop 1
    s_cmp_eq_u32 s87, 16
    s_cbranch_scc1 LA_back_22
    s_sleep 6
    s_sub_u32 s92, s92, 1
    s_cmp_lg_u32 s92, 0
    s_cbranch_scc1 LA_slow_21_l
    s_branch LA_back_22
LA_end:
L_exit:
    s_endpgm
.p2align 6
L_second:
    s_add_u32 s32, s6, s77
    s_addc_u32 s33, s7, 0
    s_sub_u32 s34, 1572864, s77
    s_mov_b32 s35, 0x20000
    s_barrier
    s_mov_b32 s52, s26
    s_mov_b32 s53, s27
    s_mov_b32 s54, 10485760
    s_mov_b32 s55, 0x20000
    v_lshlrev_b32 v246, 4, v255
    v_mov_b32 v245, 0
    s_cmp_lg_u32 s64, 0
    s_cbranch_scc1 LB_nozero_2
    s_mul_i32 s87, s63, 12288
    s_add_u32 s87, s87, 9437184
    s_lshl_b32 s88, s60, 10
    v_add_u32 v0, s88, v246
    v_mov_b32 v8, 0
    v_subrev_u32 v9, 0x880, v0
    v_cmp_gt_u32 vcc, 0x80, v9
    s_nop 1
    v_cndmask_b32 v8, v8, 1.0, vcc
    v_subrev_u32 v9, 0x1180, v0
    v_cmp_gt_u32 vcc, 0x80, v9
    s_nop 1
    v_cndmask_b32 v8, v8, 1.0, vcc
    v_subrev_u32 v9, 0x1a80, v0
    v_cmp_gt_u32 vcc, 0x80, v9
    s_nop 1
    v_cndmask_b32 v8, v8, 1.0, vcc
    v_subrev_u32 v9, 0x2380, v0
    v_cmp_gt_u32 vcc, 0x80, v9
    s_nop 1
    v_cndmask_b32 v8, v8, 1.0, vcc
    v_mov_b32 v9, v8
    v_mov_b32 v10, v8
    v_mov_b32 v11, v8
    buffer_store_dwordx4 v[8:11], v0, s[52:55], s87 offen sc1
    s_and_b32 s88, s60, 3
    s_lshl_b32 s88, s88, 10
    s_add_u32 s88, s88, 8192
    v_add_u32 v0, s88, v246
    v_mov_b32 v8, 0
    v_subrev_u32 v9, 0x880, v0
    v_cmp_gt_u32 vcc, 0x80, v9
    s_nop 1
    v_cndmask_b32 v8, v8, 1.0, vcc
    v_subrev_u32 v9, 0x1180, v0
    v_cmp_gt_u32 vcc, 0x80, v9
    s_nop 1
    v_cndmask_b32 v8, v8, 1.0, vcc
    v_subrev_u32 v9, 0x1a80, v0
    v_cmp_gt_u32 vcc, 0x80, v9
    s_nop 1
    v_cndmask_b32 v8, v8, 1.0, vcc
    v_subrev_u32 v9, 0x2380, v0
    v_cmp_gt_u32 vcc, 0x80, v9
    s_nop 1
    v_cndmask_b32 v8, v8, 1.0, vcc
    v_mov_b32 v9, v8
    v_mov_b32 v10, v8
    v_mov_b32 v11, v8
    buffer_store_dwordx4 v[8:11], v0, s[52:55], s87 offen sc1
LB_nozero_2:
    s_add_u32 m0, s68, 32768
    s_mul_i32 s76, s1, 128
    buffer_load_dwordx4 v248, s[28:31], s76 offen lds
    buffer_load_dwordx4 v247, s[28:31], s76 offen offset:1024 lds
    s_add_u32 m0, s68, 49152
    s_mul_i32 s76, s1, 229376
    buffer_load_dwordx4 v253, s[36:39], s76 offen lds
    buffer_load_dwordx4 v252, s[40:43], s76 offen offset:1024 lds
    s_mov_b32 s74, 0x3fb8aa3b
    s_mov_b32 s75, 0xbfb8aa3b
    s_lshl_b32 s87, s66, 7
    s_add_u32 s44, s18, s87
    s_addc_u32 s45, s19, 0
    s_sub_u32 s46, 1835008, s87
    s_mov_b32 s47, 0x20000
    s_add_u32 s48, s10, s87
    s_addc_u32 s49, s11, 0
    s_sub_u32 s50, 524288, s87
    s_mov_b32 s51, 0x20000
    s_lshl_b32 s88, s65, 16
    s_add_u32 s87, s87, s88
    s_add_u32 s56, s22, s87
    s_addc_u32 s57, s23, 0
    s_sub_u32 s58, 2097152, s87
    s_mov_b32 s59, 0x20000
    s_lshl_b32 s76, s63, 1
    s_add_u32 s76, s76, s62
    s_lshl_b32 s76, s76, 10
    s_mov_b32 s10, 16384
    s_mov_b32 s11, 0x20000
    s_add_u32 m0, s68, 65536
    s_nop 0
    buffer_load_dwordx4 v246, s[8:11], s76 offen lds
    s_add_u32 s12, s100, 2
    s_and_b32 s12, s12, 7
    s_add_u32 s13, s100, 3
    s_and_b32 s13, s13, 7
    s_add_u32 s18, s100, 4
    s_and_b32 s18, s18, 7
    s_add_u32 s19, s100, 5
    s_and_b32 s19, s19, 7
    s_add_u32 s22, s100, 6
    s_and_b32 s22, s22, 7
    s_add_u32 s23, s100, 7
    s_and_b32 s23, s23, 7
    s_add_u32 s6, s3, 0
    s_and_b32 s6, s6, 3
    s_lshl_b32 s6, s6, 14
    s_add_u32 s7, s3, 1
    s_and_b32 s7, s7, 3
    s_lshl_b32 s7, s7, 14
    s_add_u32 s26, s3, 2
    s_and_b32 s26, s26, 3
    s_lshl_b32 s26, s26, 14
    s_add_u32 s27, s3, 3
    s_and_b32 s27, s27, 3
    s_lshl_b32 s27, s27, 14
    s_lshl_b32 s71, s60, 17
    s_add_u32 s71, s71, 786432
    s_lshr_b32 s87, s60, 1
    s_mul_i32 s87, s87, 196608
    s_and_b32 s88, s60, 1
    s_lshl_b32 s98, s88, 17
    s_add_u32 s98, s98, s87
    s_lshl_b32 s73, s88, 15
    s_add_u32 s73, s73, s87
    s_add_u32 s73, s73, 65536
    s_lshl_b32 s72, s60, 16
    s_lshl_b32 s87, s64, 2
    s_add_u32 s87, s87, s61
    s_mul_i32 s87, s87, 144
    s_add_u32 s87, s87, s63
    s_lshl_b32 s87, s87, 10
    s_lshl_b32 s88, s62, 13
    s_add_u32 s80, s87, s88
    s_add_u32 s79, s80, s88
    s_lshl_b32 s87, s65, 1
    s_add_u32 s87, s87, s62
    s_mul_i32 s87, s87, 144
    s_lshl_b32 s88, s61, 1
    s_add_u32 s87, s87, s88
    s_lshl_b32 s81, s87, 10
    s_lshr_b32 s87, s64, 1
    s_mul_i32 s87, s87, 12288
    s_and_b32 s88, s64, 1
    s_mul_i32 s88, s88, 1280
    s_add_u32 s87, s87, s88
    s_add_u32 s84, s87, 9446656
    s_lshr_b32 s89, s65, 1
    s_lshr_b32 s87, s89, 1
    s_mul_i32 s87, s87, 12288
    s_and_b32 s88, s89, 1
    s_mul_i32 s88, s88, 1280
    s_add_u32 s87, s87, s88
    s_add_u32 s85, s87, 9446656
    s_mul_i32 s87, s63, 12288
    s_add_u32 s87, s87, 9437184
    s_add_u32 s86, s87, 9216
    s_mov_b32 s83, s87
    s_lshl_b32 s87, s61, 12
    v_bfe_u32 v0, v255, 0, 5
    v_lshl_add_u32 v2, v0, 7, s87
    v_bfe_u32 v1, v255, 1, 3
    v_lshrrev_b32 v4, 5, v255
    v_xor_b32 v1, v1, v4
    v_lshl_add_u32 v2, v1, 4, v2
    v_xor_b32 v0, 32, v2
    v_xor_b32 v1, 64, v2
    v_xor_b32 v3, 0x60, v2
    v_bfe_u32 v4, v255, 5, 1
    v_lshlrev_b32 v244, 11, v4
    v_bfe_u32 v4, v255, 4, 1
    v_lshl_add_u32 v244, v4, 10, v244
    v_bfe_u32 v4, v255, 2, 2
    v_lshl_add_u32 v244, v4, 7, v244
    v_bfe_u32 v4, v255, 0, 2
    v_lshl_add_u32 v244, v4, 3, v244
    v_bfe_u32 v4, v255, 3, 2
    v_lshl_add_u32 v244, v4, 5, v244
    s_lshl_b32 s87, s62, 6
    v_xor_b32 v244, s87, v244
    v_xor_b32 v243, 32, v244
    s_waitcnt vmcnt(5)
    s_barrier
    s_setprio 2
    ds_read_b128 v[236:239], v2
    ds_read_b64_tr_b16 v[4:5], v244 offset:16384
    ds_read_b64_tr_b16 v[6:7], v244 offset:16896
    ds_read_b64_tr_b16 v[8:9], v243 offset:16384
    ds_read_b64_tr_b16 v[10:11], v243 offset:16896
    ds_read_b128 v[232:235], v0
    ds_read_b64_tr_b16 v[12:13], v244 offset:20480
    ds_read_b64_tr_b16 v[14:15], v244 offset:20992
    s_waitcnt lgkmcnt(5)
    v_mfma_f32_32x32x16_bf16 v[16:31], v[4:7], v[236:239], 0
    ds_read_b64_tr_b16 v[4:5], v243 offset:20480
    ds_read_b64_tr_b16 v[6:7], v243 offset:20992
    s_waitcnt lgkmcnt(5)
    v_mfma_f32_32x32x16_bf16 v[216:231], v[8:11], v[236:239], 0
    s_setprio 1
    ds_read_b128 v[212:215], v1
    ds_read_b64_tr_b16 v[8:9], v244 offset:24576
    ds_read_b64_tr_b16 v[10:11], v244 offset:25088
    s_waitcnt lgkmcnt(5)
    v_mfma_f32_32x32x16_bf16 v[16:31], v[12:15], v[232:235], v[16:31]
    ds_read_b64_tr_b16 v[12:13], v243 offset:24576
    ds_read_b64_tr_b16 v[14:15], v243 offset:25088
    s_waitcnt lgkmcnt(5)
    v_mfma_f32_32x32x16_bf16 v[216:231], v[4:7], v[232:235], v[216:231]
    s_setprio 0
    ds_read_b128 v[208:211], v3
    ds_read_b64_tr_b16 v[4:5], v244 offset:28672
    ds_read_b64_tr_b16 v[6:7], v244 offset:29184
    s_waitcnt lgkmcnt(5)
    v_mfma_f32_32x32x16_bf16 v[16:31], v[8:11], v[212:215], v[16:31]
    ds_read_b64_tr_b16 v[8:9], v243 offset:28672
    ds_read_b64_tr_b16 v[10:11], v243 offset:29184
    s_waitcnt lgkmcnt(5)
    v_mfma_f32_32x32x16_bf16 v[216:231], v[12:15], v[212:215], v[216:231]
    s_waitcnt vmcnt(1) lgkmcnt(0)
    s_barrier
    s_setprio 3
    v_mov_b32 v12, 1
    s_lshl_b32 s78, s63, 2
    v_mov_b32 v13, s78
    s_or_b32 s78, s64, s60
    s_cmp_lg_u32 s78, 0
    s_cbranch_scc1 LB_nof0_6
    global_store_dword v13, v12, s[24:25] sc1
LB_nof0_6:
    ds_read_b128 v[204:207], v2 offset:32768
    ds_read_b64_tr_b16 v[12:13], v244 offset:49152
    ds_read_b64_tr_b16 v[14:15], v244 offset:49664
    v_mfma_f32_32x32x16_bf16 v[16:31], v[4:7], v[208:211], v[16:31]
    s_add_u32 m0, s68, 81920
    s_mul_i32 s76, s12, 128
    buffer_load_dwordx4 v248, s[28:31], s76 offen lds
    ds_read_b64_tr_b16 v[4:5], v243 offset:49152
    ds_read_b64_tr_b16 v[6:7], v243 offset:49664
    v_mfma_f32_32x32x16_bf16 v[216:231], v[8:11], v[208:211], v[216:231]
    s_setprio 2
    buffer_load_dwordx4 v247, s[28:31], s76 offen offset:1024 lds
    ds_read_b128 v[200:203], v0 offset:32768
    ds_read_b64_tr_b16 v[8:9], v244 offset:53248
    ds_read_b64_tr_b16 v[10:11], v244 offset:53760
    s_waitcnt lgkmcnt(5)
    v_mfma_f32_32x32x16_bf16 v[16:31], v[12:15], v[204:207], v[16:31]
    s_add_u32 m0, s68, 98304
    s_mul_i32 s76, s12, 229376
    buffer_load_dwordx4 v253, s[36:39], s76 offen lds
    ds_read_b64_tr_b16 v[12:13], v243 offset:53248
    ds_read_b64_tr_b16 v[14:15], v243 offset:53760
    s_waitcnt lgkmcnt(5)
    v_mfma_f32_32x32x16_bf16 v[216:231], v[4:7], v[204:207], v[216:231]
    s_setprio 1
    buffer_load_dwordx4 v252, s[40:43], s76 offen offset:1024 lds
    ds_read_b128 v[196:199], v1 offset:32768
    ds_read_b64_tr_b16 v[4:5], v244 offset:57344
    ds_read_b64_tr_b16 v[6:7], v244 offset:57856
    s_waitcnt lgkmcnt(5)
    v_mfma_f32_32x32x16_bf16 v[16:31], v[8:11], v[200:203], v[16:31]
    s_add_u32 m0, s68, 114688
    s_mul_i32 s76, s13, 128
    buffer_load_dwordx4 v248, s[28:31], s76 offen lds
    ds_read_b64_tr_b16 v[8:9], v243 offset:57344
    ds_read_b64_tr_b16 v[10:11], v243 offset:57856
    s_waitcnt lgkmcnt(5)
    v_mfma_f32_32x32x16_bf16 v[216:231], v[12:15], v[200:203], v[216:231]
    s_setprio 0
    buffer_load_dwordx4 v247, s[28:31], s76 offen offset:1024 lds
    ds_read_b128 v[192:195], v3 offset:32768
    ds_read_b64_tr_b16 v[12:13], v244 offset:61440
    ds_read_b64_tr_b16 v[14:15], v244 offset:61952
    s_waitcnt lgkmcnt(5)
    v_mfma_f32_32x32x16_bf16 v[16:31], v[4:7], v[196:199], v[16:31]
    ds_read_b64_tr_b16 v[4:5], v243 offset:61440
    ds_read_b64_tr_b16 v[6:7], v243 offset:61952
    s_waitcnt lgkmcnt(5)
    v_mfma_f32_32x32x16_bf16 v[216:231], v[8:11], v[196:199], v[216:231]
    s_waitcnt vmcnt(2) lgkmcnt(0)
    s_barrier
    s_setprio 3
    v_add_u32 v8, 0x10000, v2
    ds_read_b128 v[188:191], v8 offset:16384
    v_add_u32 v242, 0x10000, v244
    ds_read_b64_tr_b16 v[32:33], v242 offset:32768
    ds_read_b64_tr_b16 v[34:35], v242 offset:33280
    v_mfma_f32_32x32x16_bf16 v[16:31], v[12:15], v[192:195], v[16:31]
    s_add_u32 m0, s68, 131072
    s_mul_i32 s76, s13, 229376
    buffer_load_dwordx4 v253, s[36:39], s76 offen lds
    v_add_u32 v241, 0x10000, v243
    ds_read_b64_tr_b16 v[12:13], v241 offset:32768
    ds_read_b64_tr_b16 v[14:15], v241 offset:33280
    v_mfma_f32_32x32x16_bf16 v[216:231], v[4:7], v[192:195], v[216:231]
    s_setprio 2
    buffer_load_dwordx4 v252, s[40:43], s76 offen offset:1024 lds
    v_add_u32 v4, 0x10000, v0
    ds_read_b128 v[184:187], v4 offset:16384
    ds_read_b64_tr_b16 v[36:37], v242 offset:36864
    ds_read_b64_tr_b16 v[38:39], v242 offset:37376
    s_waitcnt lgkmcnt(5)
    v_mfma_f32_32x32x16_bf16 v[16:31], v[32:35], v[188:191], v[16:31]
    s_add_u32 m0, s68, 147456
    s_mul_i32 s76, s18, 128
    buffer_load_dwordx4 v248, s[28:31], s76 offen lds
    ds_read_b64_tr_b16 v[32:33], v241 offset:36864
    ds_read_b64_tr_b16 v[34:35], v241 offset:37376
    s_waitcnt lgkmcnt(5)
    v_mfma_f32_32x32x16_bf16 v[216:231], v[12:15], v[188:191], v[216:231]
    s_setprio 1
    buffer_load_dwordx4 v247, s[28:31], s76 offen offset:1024 lds
    v_add_u32 v5, 0x10000, v1
    ds_read_b128 v[180:183], v5 offset:16384
    ds_read_b64_tr_b16 v[12:13], v242 offset:40960
    ds_read_b64_tr_b16 v[14:15], v242 offset:41472
    s_waitcnt lgkmcnt(5)
    v_mfma_f32_32x32x16_bf16 v[16:31], v[36:39], v[184:187], v[16:31]
    s_add_u32 m0, s68, 0
    s_mul_i32 s76, s18, 229376
    buffer_load_dwordx4 v253, s[36:39], s76 offen lds
    ds_read_b64_tr_b16 v[36:37], v241 offset:40960
    ds_read_b64_tr_b16 v[38:39], v241 offset:41472
    s_waitcnt lgkmcnt(5)
    v_mfma_f32_32x32x16_bf16 v[216:231], v[32:35], v[184:187], v[216:231]
    s_setprio 0
    buffer_load_dwordx4 v252, s[40:43], s76 offen offset:1024 lds
    v_add_u32 v6, 0x10000, v3
    ds_read_b128 v[176:179], v6 offset:16384
    ds_read_b64_tr_b16 v[32:33], v242 offset:45056
    ds_read_b64_tr_b16 v[34:35], v242 offset:45568
    s_waitcnt lgkmcnt(5)
    v_mfma_f32_32x32x16_bf16 v[16:31], v[12:15], v[180:183], v[16:31]
    ds_read_b64_tr_b16 v[12:13], v241 offset:45056
    ds_read_b64_tr_b16 v[14:15], v241 offset:45568
    s_waitcnt lgkmcnt(5)
    v_mfma_f32_32x32x16_bf16 v[216:231], v[36:39], v[180:183], v[216:231]
    s_waitcnt vmcnt(4) lgkmcnt(0)
    s_barrier
    s_setprio 3
    ds_read_b128 v[172:175], v8 offset:49152
    v_add_u32 v240, 0x20000, v244
    ds_read_b64_tr_b16 v[36:37], v240
    ds_read_b64_tr_b16 v[38:39], v240 offset:512
    v_mfma_f32_32x32x16_bf16 v[16:31], v[32:35], v[176:179], v[16:31]
    s_add_u32 m0, s68, 16384
    s_mul_i32 s76, s19, 128
    buffer_load_dwordx4 v248, s[28:31], s76 offen lds
    s_add_u32 s78, s68, 65536
    v_bfe_u32 v7, v255, 0, 1
    v_lshl_add_u32 v9, v7, 9, s78
    v_add_u32 v171, 0x20000, v243
    ds_read_b64_tr_b16 v[32:33], v171
    ds_read_b64_tr_b16 v[34:35], v171 offset:512
    v_mfma_f32_32x32x16_bf16 v[216:231], v[12:15], v[176:179], v[216:231]
    s_setprio 2
    buffer_load_dwordx4 v247, s[28:31], s76 offen offset:1024 lds
    v_bfe_u32 v7, v255, 5, 1
    v_lshl_add_u32 v9, v7, 7, v9
    v_bfe_u32 v7, v255, 2, 2
    ds_read_b128 v[164:167], v4 offset:49152
    ds_read_b64_tr_b16 v[12:13], v240 offset:4096
    ds_read_b64_tr_b16 v[14:15], v240 offset:4608
    s_waitcnt lgkmcnt(5)
    v_mfma_f32_32x32x16_bf16 v[16:31], v[36:39], v[172:175], v[16:31]
    s_add_u32 m0, s68, 32768
    s_mul_i32 s76, s19, 229376
    buffer_load_dwordx4 v253, s[36:39], s76 offen lds
    v_lshl_add_u32 v9, v7, 5, v9
    v_bfe_u32 v7, v255, 4, 1
    ds_read_b64_tr_b16 v[36:37], v171 offset:4096
    ds_read_b64_tr_b16 v[38:39], v171 offset:4608
    s_waitcnt lgkmcnt(5)
    v_mfma_f32_32x32x16_bf16 v[216:231], v[32:35], v[172:175], v[216:231]
    s_setprio 1
    buffer_load_dwordx4 v252, s[40:43], s76 offen offset:1024 lds
    v_lshl_add_u32 v9, v7, 4, v9
    v_bfe_u32 v7, v255, 1, 1
    ds_read_b128 v[160:163], v5 offset:49152
    ds_read_b64_tr_b16 v[32:33], v240 offset:8192
    ds_read_b64_tr_b16 v[34:35], v240 offset:8704
    s_waitcnt lgkmcnt(5)
    v_mfma_f32_32x32x16_bf16 v[16:31], v[12:15], v[164:167], v[16:31]
    s_add_u32 m0, s68, 49152
    s_mul_i32 s76, s22, 128
    buffer_load_dwordx4 v248, s[28:31], s76 offen lds
    v_lshl_add_u32 v9, v7, 3, v9
    ds_read_b64_tr_b16 v[12:13], v9
    ds_read_b64_tr_b16 v[14:15], v9 offset:256
    ds_read_b64_tr_b16 v[40:41], v171 offset:8192
    ds_read_b64_tr_b16 v[42:43], v171 offset:8704
    s_waitcnt lgkmcnt(7)
    v_mfma_f32_32x32x16_bf16 v[216:231], v[36:39], v[164:167], v[216:231]
    s_setprio 0
    buffer_load_dwordx4 v247, s[28:31], s76 offen offset:1024 lds
    ds_read_b128 v[156:159], v6 offset:49152
    ds_read_b64_tr_b16 v[36:37], v240 offset:12288
    ds_read_b64_tr_b16 v[38:39], v240 offset:12800
    s_waitcnt lgkmcnt(7)
    v_mfma_f32_32x32x16_bf16 v[16:31], v[32:35], v[160:163], v[16:31]
    s_waitcnt lgkmcnt(6)
    v_lshlrev_b32 v32, 16, v12
    v_and_b32 v12, 0xffff0000, v12
    v_mul_f32 v32, s74, v32
    ds_read_b64_tr_b16 v[44:45], v171 offset:12288
    ds_read_b64_tr_b16 v[46:47], v171 offset:12800
    s_waitcnt lgkmcnt(5)
    v_mfma_f32_32x32x16_bf16 v[216:231], v[40:43], v[160:163], v[216:231]
    v_mul_f32 v12, s74, v12
    v_cvt_pk_bf16_f32 v12, v32, v12
    v_lshlrev_b32 v33, 16, v13
    s_waitcnt vmcnt(6) lgkmcnt(0)
    s_barrier
    s_setprio 3
    v_add_u32 v7, 0x20000, v2
    ds_read_b128 v[152:155], v7 offset:16384
    ds_read_b64_tr_b16 v[40:41], v244
    ds_read_b64_tr_b16 v[42:43], v244 offset:512
    v_mfma_f32_32x32x16_bf16 v[16:31], v[36:39], v[156:159], v[16:31]
    s_add_u32 m0, s68, 81920
    s_mul_i32 s76, s22, 229376
    buffer_load_dwordx4 v253, s[36:39], s76 offen lds
    v_and_b32 v13, 0xffff0000, v13
    v_mul_f32 v33, s74, v33
    v_mul_f32 v13, s74, v13
    ds_read_b64_tr_b16 v[36:37], v243
    ds_read_b64_tr_b16 v[38:39], v243 offset:512
    v_mfma_f32_32x32x16_bf16 v[216:231], v[44:47], v[156:159], v[216:231]
    s_setprio 2
    buffer_load_dwordx4 v252, s[40:43], s76 offen offset:1024 lds
    v_cvt_pk_bf16_f32 v13, v33, v13
    v_lshlrev_b32 v34, 16, v14
    v_add_u32 v7, 0x20000, v0
    ds_read_b128 v[148:151], v7 offset:16384
    ds_read_b64_tr_b16 v[44:45], v244 offset:4096
    ds_read_b64_tr_b16 v[46:47], v244 offset:4608
    s_waitcnt lgkmcnt(5)
    v_mfma_f32_32x32x16_bf16 v[16:31], v[40:43], v[152:155], v[16:31]
    s_add_u32 m0, s68, 98304
    s_mul_i32 s76, s23, 128
    buffer_load_dwordx4 v248, s[28:31], s76 offen lds
    v_and_b32 v14, 0xffff0000, v14
    v_mul_f32 v34, s74, v34
    v_mul_f32 v14, s74, v14
    ds_read_b64_tr_b16 v[40:41], v243 offset:4096
    ds_read_b64_tr_b16 v[42:43], v243 offset:4608
    s_waitcnt lgkmcnt(5)
    v_mfma_f32_32x32x16_bf16 v[216:231], v[36:39], v[152:155], v[216:231]
    s_setprio 1
    buffer_load_dwordx4 v247, s[28:31], s76 offen offset:1024 lds
    v_cvt_pk_bf16_f32 v14, v34, v14
    v_lshlrev_b32 v35, 16, v15
    v_and_b32 v15, 0xffff0000, v15
    v_add_u32 v7, 0x20000, v1
    ds_read_b128 v[144:147], v7 offset:16384
    ds_read_b64_tr_b16 v[36:37], v244 offset:8192
    ds_read_b64_tr_b16 v[38:39], v244 offset:8704
    s_waitcnt lgkmcnt(5)
    v_mfma_f32_32x32x16_bf16 v[16:31], v[44:47], v[148:151], v[16:31]
    s_add_u32 m0, s68, 65536
    s_mul_i32 s76, s23, 229376
    buffer_load_dwordx4 v253, s[36:39], s76 offen lds
    v_mul_f32 v35, s74, v35
    v_mul_f32 v15, s74, v15
    ds_read_b64_tr_b16 v[44:45], v243 offset:8192
    ds_read_b64_tr_b16 v[46:47], v243 offset:8704
    s_waitcnt lgkmcnt(5)
    v_mfma_f32_32x32x16_bf16 v[216:231], v[40:43], v[148:151], v[216:231]
    s_setprio 0
    buffer_load_dwordx4 v252, s[40:43], s76 offen offset:1024 lds
    v_cvt_pk_bf16_f32 v15, v35, v15
    v_and_b32 v7, 4, v255
    v_cmp_eq_u32 s[90:91], 0, v7
    v_add_u32 v7, 0x20000, v3
    ds_read_b128 v[140:143], v7 offset:16384
    ds_read_b64_tr_b16 v[32:33], v244 offset:12288
    ds_read_b64_tr_b16 v[34:35], v244 offset:12800
    s_waitcnt lgkmcnt(5)
    v_mfma_f32_32x32x16_bf16 v[16:31], v[36:39], v[144:147], v[16:31]
    v_cndmask_b32 v136, 0, v12, s[90:91]
    v_cndmask_b32 v137, 0, v13, s[90:91]
    ds_read_b64_tr_b16 v[36:37], v243 offset:12288
    ds_read_b64_tr_b16 v[38:39], v243 offset:12800
    s_waitcnt lgkmcnt(5)
    v_mfma_f32_32x32x16_bf16 v[216:231], v[44:47], v[144:147], v[216:231]
    v_cndmask_b32 v138, 0, v14, s[90:91]
    v_cndmask_b32 v139, 0, v15, s[90:91]
    s_waitcnt vmcnt(8) lgkmcnt(0)
    s_barrier
    s_setprio 3
    ds_read_b128 v[132:135], v2 offset:16384
    ds_read_b64_tr_b16 v[40:41], v244 offset:32768
    ds_read_b64_tr_b16 v[42:43], v244 offset:33280
    v_mfma_f32_32x32x16_bf16 v[16:31], v[32:35], v[140:143], v[16:31]
    s_add_u32 m0, s68, 114688
    s_mul_i32 s76, s0, 196608
    buffer_load_dwordx4 v249, s[32:35], s76 offen lds
    v_cndmask_b32 v128, v12, 0, s[90:91]
    v_cndmask_b32 v129, v13, 0, s[90:91]
    ds_read_b64_tr_b16 v[32:33], v243 offset:32768
    ds_read_b64_tr_b16 v[34:35], v243 offset:33280
    v_mfma_f32_32x32x16_bf16 v[216:231], v[36:39], v[140:143], v[216:231]
    s_setprio 2
    s_add_u32 m0, s68, 115712
    s_mul_i32 s76, s1, 196608
    buffer_load_dwordx4 v249, s[32:35], s76 offen lds
    v_cndmask_b32 v130, v14, 0, s[90:91]
    v_cndmask_b32 v131, v15, 0, s[90:91]
    ds_read_b128 v[124:127], v0 offset:16384
    ds_read_b64_tr_b16 v[12:13], v244 offset:36864
    ds_read_b64_tr_b16 v[14:15], v244 offset:37376
    s_waitcnt lgkmcnt(5)
    v_mfma_f32_32x32x16_bf16 v[16:31], v[40:43], v[132:135], v[16:31]
    ds_read_b64_tr_b16 v[36:37], v243 offset:36864
    ds_read_b64_tr_b16 v[38:39], v243 offset:37376
    s_waitcnt lgkmcnt(5)
    v_mfma_f32_32x32x16_bf16 v[216:231], v[32:35], v[132:135], v[216:231]
    s_setprio 1
    ds_read_b128 v[120:123], v1 offset:16384
    ds_read_b64_tr_b16 v[32:33], v244 offset:40960
    ds_read_b64_tr_b16 v[34:35], v244 offset:41472
    s_waitcnt lgkmcnt(5)
    v_mfma_f32_32x32x16_bf16 v[16:31], v[12:15], v[124:127], v[16:31]
    ds_read_b64_tr_b16 v[12:13], v243 offset:40960
    ds_read_b64_tr_b16 v[14:15], v243 offset:41472
    s_waitcnt lgkmcnt(5)
    v_mfma_f32_32x32x16_bf16 v[216:231], v[36:39], v[124:127], v[216:231]
    s_setprio 0
    ds_read_b128 v[116:119], v3 offset:16384
    ds_read_b64_tr_b16 v[36:37], v244 offset:45056
    ds_read_b64_tr_b16 v[38:39], v244 offset:45568
    s_waitcnt lgkmcnt(5)
    v_mfma_f32_32x32x16_bf16 v[16:31], v[32:35], v[120:123], v[16:31]
    ds_read_b64_tr_b16 v[32:33], v243 offset:45056
    ds_read_b64_tr_b16 v[34:35], v243 offset:45568
    s_waitcnt lgkmcnt(5)
    v_mfma_f32_32x32x16_bf16 v[216:231], v[12:15], v[120:123], v[216:231]
    s_waitcnt vmcnt(6) lgkmcnt(0)
    s_barrier
    s_setprio 3
    ds_read_b128 v[112:115], v2 offset:49152
    ds_read_b64_tr_b16 v[12:13], v242 offset:16384
    ds_read_b64_tr_b16 v[14:15], v242 offset:16896
    v_mfma_f32_32x32x16_bf16 v[16:31], v[36:39], v[116:119], v[16:31]
    s_add_u32 m0, s68, 131072
    s_mul_i32 s76, s12, 196608
    buffer_load_dwordx4 v249, s[32:35], s76 offen lds
    ds_read_b64_tr_b16 v[36:37], v241 offset:16384
    ds_read_b64_tr_b16 v[38:39], v241 offset:16896
    v_mfma_f32_32x32x16_bf16 v[216:231], v[32:35], v[116:119], v[216:231]
    s_setprio 2
    s_add_u32 m0, s68, 132096
    s_mul_i32 s76, s13, 196608
    buffer_load_dwordx4 v249, s[32:35], s76 offen lds
    ds_read_b128 v[108:111], v0 offset:49152
    ds_read_b64_tr_b16 v[32:33], v242 offset:20480
    ds_read_b64_tr_b16 v[34:35], v242 offset:20992
    s_waitcnt lgkmcnt(5)
    v_mfma_f32_32x32x16_bf16 v[16:31], v[12:15], v[112:115], v[16:31]
    s_add_u32 m0, s68, 147456
    s_mul_i32 s76, s18, 196608
    buffer_load_dwordx4 v249, s[32:35], s76 offen lds
    ds_read_b64_tr_b16 v[12:13], v241 offset:20480
    ds_read_b64_tr_b16 v[14:15], v241 offset:20992
    s_waitcnt lgkmcnt(5)
    v_mfma_f32_32x32x16_bf16 v[216:231], v[36:39], v[112:115], v[216:231]
    s_setprio 1
    s_add_u32 m0, s68, 148480
    s_mul_i32 s76, s19, 196608
    buffer_load_dwordx4 v249, s[32:35], s76 offen lds
    ds_read_b128 v[104:107], v1 offset:49152
    ds_read_b64_tr_b16 v[36:37], v242 offset:24576
    ds_read_b64_tr_b16 v[38:39], v242 offset:25088
    s_waitcnt lgkmcnt(5)
    v_mfma_f32_32x32x16_bf16 v[16:31], v[32:35], v[108:111], v[16:31]
    s_add_u32 m0, s68, 0
    s_mul_i32 s76, s22, 196608
    buffer_load_dwordx4 v249, s[32:35], s76 offen lds
    ds_read_b64_tr_b16 v[32:33], v241 offset:24576
    ds_read_b64_tr_b16 v[34:35], v241 offset:25088
    s_waitcnt lgkmcnt(5)
    v_mfma_f32_32x32x16_bf16 v[216:231], v[12:15], v[108:111], v[216:231]
    s_setprio 0
    s_add_u32 m0, s68, 1024
    s_mul_i32 s76, s23, 196608
    buffer_load_dwordx4 v249, s[32:35], s76 offen lds
    ds_read_b128 v[100:103], v3 offset:49152
    ds_read_b64_tr_b16 v[0:1], v242 offset:28672
    ds_read_b64_tr_b16 v[2:3], v242 offset:29184
    s_waitcnt lgkmcnt(5)
    v_mfma_f32_32x32x16_bf16 v[16:31], v[36:39], v[104:107], v[16:31]
    ds_read_b64_tr_b16 v[12:13], v241 offset:28672
    ds_read_b64_tr_b16 v[14:15], v241 offset:29184
    s_waitcnt lgkmcnt(5)
    v_mfma_f32_32x32x16_bf16 v[216:231], v[32:35], v[104:107], v[216:231]
    s_mov_b32 s78, s2
    s_mul_i32 s99, s78, 9216
    s_lshl_b32 s89, s60, 7
    s_add_u32 s99, s99, s89
    s_sub_u32 s89, s99, 1835008
    s_cmp_lt_u32 s78, 200
    s_cselect_b32 s99, s99, s89
    s_cselect_b64 s[8:9], s[44:45], s[48:49]
    s_cselect_b32 s10, s46, s50
    v_lshlrev_b32 v7, 10, v255
    s_add_u32 s78, s2, 0
    s_and_b32 s78, s78, 0
    s_mul_i32 s78, s78, 9216
    s_add_u32 s78, s78, s99
    s_mov_b64 exec, 0x1ff
    buffer_load_dword v254, v7, s[8:11], s78 offen
    s_mov_b64 exec, -1
    s_waitcnt vmcnt(9) lgkmcnt(0)
    s_barrier
    s_setprio 3
    ds_read_b128 v[96:99], v8 offset:32768
    ds_read_b64_tr_b16 v[8:9], v242
    ds_read_b64_tr_b16 v[10:11], v242 offset:512
    v_mfma_f32_32x32x16_bf16 v[16:31], v[0:3], v[100:103], v[16:31]
    s_add_u32 m0, s68, 16384
    s_mul_i32 s76, s0, 229376
    s_add_u32 s76, s76, 128
    buffer_load_dwordx4 v253, s[36:39], s76 offen lds
    ds_read_b64_tr_b16 v[0:1], v241
    ds_read_b64_tr_b16 v[2:3], v241 offset:512
    v_mfma_f32_32x32x16_bf16 v[216:231], v[12:15], v[100:103], v[216:231]
    s_setprio 2
    buffer_load_dwordx4 v252, s[40:43], s76 offen offset:1024 lds
    ds_read_b128 v[92:95], v4 offset:32768
    ds_read_b64_tr_b16 v[12:13], v242 offset:4096
    ds_read_b64_tr_b16 v[14:15], v242 offset:4608
    s_waitcnt lgkmcnt(5)
    v_mfma_f32_32x32x16_bf16 v[16:31], v[8:11], v[96:99], v[16:31]
    v_bfe_u32 v4, v255, 5, 1
    v_lshlrev_b32 v7, 11, v4
    v_bfe_u32 v4, v255, 2, 2
    ds_read_b64_tr_b16 v[8:9], v241 offset:4096
    ds_read_b64_tr_b16 v[10:11], v241 offset:4608
    s_waitcnt lgkmcnt(5)
    v_mfma_f32_32x32x16_bf16 v[216:231], v[0:3], v[96:99], v[216:231]
    s_setprio 1
    v_lshl_add_u32 v7, v4, 7, v7
    v_bfe_u32 v4, v255, 3, 1
    ds_read_b128 v[88:91], v5 offset:32768
    ds_read_b64_tr_b16 v[0:1], v242 offset:8192
    ds_read_b64_tr_b16 v[2:3], v242 offset:8704
    s_waitcnt lgkmcnt(5)
    v_mfma_f32_32x32x16_bf16 v[16:31], v[12:15], v[92:95], v[16:31]
    v_lshl_add_u32 v7, v4, 6, v7
    v_bfe_u32 v4, v255, 4, 1
    ds_read_b64_tr_b16 v[12:13], v241 offset:8192
    ds_read_b64_tr_b16 v[14:15], v241 offset:8704
    s_waitcnt lgkmcnt(5)
    v_mfma_f32_32x32x16_bf16 v[216:231], v[8:11], v[92:95], v[216:231]
    s_setprio 0
    v_lshl_add_u32 v7, v4, 5, v7
    v_bfe_u32 v4, v255, 0, 2
    ds_read_b128 v[84:87], v6 offset:32768
    ds_read_b64_tr_b16 v[8:9], v242 offset:12288
    ds_read_b64_tr_b16 v[10:11], v242 offset:12800
    s_waitcnt lgkmcnt(5)
    v_mfma_f32_32x32x16_bf16 v[16:31], v[0:3], v[88:91], v[16:31]
    v_lshl_add_u32 v7, v4, 3, v7
    s_lshl_b32 s87, s62, 6
    v_xor_b32 v7, s87, v7
    ds_read_b64_tr_b16 v[0:1], v241 offset:12288
    ds_read_b64_tr_b16 v[2:3], v241 offset:12800
    s_waitcnt lgkmcnt(5)
    v_mfma_f32_32x32x16_bf16 v[216:231], v[12:15], v[88:91], v[216:231]
    s_waitcnt vmcnt(7) lgkmcnt(0)
    s_barrier
    s_setprio 3
    v_add_u32 v4, 0x10000, v7
    ds_read_b64_tr_b16 v[12:13], v4 offset:49152
    ds_read_b64_tr_b16 v[14:15], v4 offset:49664
    v_mfma_f32_32x32x16_bf16 v[16:31], v[8:11], v[84:87], v[16:31]
    ds_read_b64_tr_b16 v[8:9], v4 offset:53248
    ds_read_b64_tr_b16 v[10:11], v4 offset:53760
    v_mfma_f32_32x32x16_bf16 v[216:231], v[0:3], v[84:87], v[216:231]
    s_setprio 2
    ds_read_b64_tr_b16 v[0:1], v4 offset:57344
    ds_read_b64_tr_b16 v[2:3], v4 offset:57856
    s_waitcnt lgkmcnt(4)
    v_mfma_f32_32x32x16_bf16 v[68:83], v[12:15], v[236:239], 0
    s_lshl_b32 s87, s64, 3
    s_add_u32 s87, s87, s63
    s_lshl_b32 s87, s87, 3
    s_add_u32 s87, s87, s60
    s_lshl_b32 s93, s87, 3
    s_add_u32 s93, s93, 9568256
    s_lshl_b32 s87, s87, 11
    v_bfe_u32 v5, v255, 0, 5
    v_lshlrev_b32 v6, 4, v5
    v_bfe_u32 v5, v255, 5, 1
    v_lshl_add_u32 v12, v5, 10, v6
    v_add_u32 v12, s87, v12
    ds_read_b64_tr_b16 v[32:33], v4 offset:61440
    ds_read_b64_tr_b16 v[34:35], v4 offset:61952
    s_waitcnt lgkmcnt(4)
    v_mfma_f32_32x32x16_bf16 v[68:83], v[8:11], v[232:235], v[68:83]
    s_setprio 1
    v_mul_f32 v16, s75, v16
    v_mul_f32 v17, s75, v17
    v_mul_f32 v18, s75, v18
    v_mul_f32 v19, s75, v19
    v_mul_f32 v20, s75, v20
    v_mul_f32 v21, s75, v21
    v_mul_f32 v22, s75, v22
    ds_read_b64_tr_b16 v[8:9], v4 offset:50176
    ds_read_b64_tr_b16 v[10:11], v4 offset:50688
    s_waitcnt lgkmcnt(4)
    v_mfma_f32_32x32x16_bf16 v[68:83], v[0:3], v[212:215], v[68:83]
    global_load_dwordx4 v[36:39], v12, s[4:5]
    v_mul_f32 v23, s75, v23
    v_exp_f32 v16, v16
    v_exp_f32 v17, v17
    ds_read_b64_tr_b16 v[0:1], v4 offset:54272
    ds_read_b64_tr_b16 v[2:3], v4 offset:54784
    s_waitcnt lgkmcnt(4)
    v_mfma_f32_32x32x16_bf16 v[68:83], v[32:35], v[208:211], v[68:83]
    s_setprio 0
    global_load_dwordx4 v[40:43], v12, s[4:5] offset:512
    global_load_dwordx4 v[44:47], v6, s[20:21]
    global_load_dwordx4 v[48:51], v6, s[20:21] offset:512
    v_exp_f32 v18, v18
    v_exp_f32 v19, v19
    ds_read_b64_tr_b16 v[12:13], v4 offset:58368
    ds_read_b64_tr_b16 v[14:15], v4 offset:58880
    s_waitcnt lgkmcnt(4)
    v_mfma_f32_32x32x16_bf16 v[68:83], v[8:11], v[204:207], v[68:83]
    v_exp_f32 v20, v20
    v_exp_f32 v21, v21
    ds_read_b64_tr_b16 v[8:9], v4 offset:62464
    ds_read_b64_tr_b16 v[10:11], v4 offset:62976
    s_waitcnt lgkmcnt(4)
    v_mfma_f32_32x32x16_bf16 v[68:83], v[0:3], v[200:203], v[68:83]
    v_bfe_u32 v0, v255, 0, 3
    v_lshlrev_b32 v1, 2, v0
    s_cmp_lg_u32 s60, 0
    s_cbranch_scc1 LB_np_5
    global_load_dword v0, v1, s[24:25] sc1
LB_np_5:
    v_exp_f32 v22, v22
    v_exp_f32 v23, v23
    v_add_u32 v2, 0x20000, v7
    ds_read_b64_tr_b16 v[32:33], v2
    ds_read_b64_tr_b16 v[34:35], v2 offset:512
    s_waitcnt lgkmcnt(4)
    v_mfma_f32_32x32x16_bf16 v[68:83], v[12:15], v[196:199], v[68:83]
    v_add_f32 v16, 1.0, v16
    v_add_f32 v17, 1.0, v17
    v_add_f32 v18, 1.0, v18
    v_add_f32 v19, 1.0, v19
    v_add_f32 v20, 1.0, v20
    ds_read_b64_tr_b16 v[12:13], v2 offset:4096
    ds_read_b64_tr_b16 v[14:15], v2 offset:4608
    s_waitcnt lgkmcnt(4)
    v_mfma_f32_32x32x16_bf16 v[68:83], v[8:11], v[192:195], v[68:83]
    s_setprio 2
    v_add_f32 v21, 1.0, v21
    v_add_f32 v22, 1.0, v22
    v_add_f32 v23, 1.0, v23
    v_rcp_f32 v16, v16
    ds_read_b64_tr_b16 v[8:9], v2 offset:8192
    ds_read_b64_tr_b16 v[10:11], v2 offset:8704
    s_waitcnt lgkmcnt(4)
    v_mfma_f32_32x32x16_bf16 v[68:83], v[32:35], v[188:191], v[68:83]
    v_rcp_f32 v17, v17
    v_rcp_f32 v18, v18
    ds_read_b64_tr_b16 v[32:33], v2 offset:12288
    ds_read_b64_tr_b16 v[34:35], v2 offset:12800
    s_waitcnt lgkmcnt(4)
    v_mfma_f32_32x32x16_bf16 v[68:83], v[12:15], v[184:187], v[68:83]
    s_setprio 1
    v_rcp_f32 v19, v19
    v_rcp_f32 v20, v20
    ds_read_b64_tr_b16 v[12:13], v2 offset:1024
    ds_read_b64_tr_b16 v[14:15], v2 offset:1536
    s_waitcnt lgkmcnt(4)
    v_mfma_f32_32x32x16_bf16 v[68:83], v[8:11], v[180:183], v[68:83]
    v_rcp_f32 v21, v21
    v_rcp_f32 v22, v22
    v_rcp_f32 v23, v23
    ds_read_b64_tr_b16 v[8:9], v2 offset:5120
    ds_read_b64_tr_b16 v[10:11], v2 offset:5632
    s_waitcnt lgkmcnt(4)
    v_mfma_f32_32x32x16_bf16 v[68:83], v[32:35], v[176:179], v[68:83]
    s_setprio 0
    v_mul_f32 v24, v16, v24
    v_mul_f32 v25, v17, v25
    v_mul_f32 v26, v18, v26
    v_mul_f32 v27, v19, v27
    ds_read_b64_tr_b16 v[32:33], v2 offset:9216
    ds_read_b64_tr_b16 v[34:35], v2 offset:9728
    s_waitcnt lgkmcnt(4)
    v_mfma_f32_32x32x16_bf16 v[68:83], v[12:15], v[172:175], v[68:83]
    v_mul_f32 v28, v20, v28
    v_mul_f32 v29, v21, v29
    v_mul_f32 v30, v22, v30
    v_mul_f32 v31, v23, v31
    v_cvt_pk_bf16_f32 v16, v24, v25
    ds_read_b64_tr_b16 v[12:13], v2 offset:13312
    ds_read_b64_tr_b16 v[14:15], v2 offset:13824
    s_waitcnt lgkmcnt(4)
    v_mfma_f32_32x32x16_bf16 v[68:83], v[8:11], v[164:167], v[68:83]
    v_cvt_pk_bf16_f32 v17, v26, v27
    v_cvt_pk_bf16_f32 v18, v28, v29
    v_cvt_pk_bf16_f32 v19, v30, v31
    s_add_u32 s78, s79, 0
    buffer_store_dwordx4 v[16:19], v246, s[52:55], s78 offen sc1
    s_waitcnt vmcnt(8) lgkmcnt(0)
    s_barrier
    s_setprio 3
    ds_read_b64_tr_b16 v[8:9], v2 offset:16384
    ds_read_b64_tr_b16 v[10:11], v2 offset:16896
    v_mfma_f32_32x32x16_bf16 v[68:83], v[32:35], v[160:163], v[68:83]
    s_add_u32 m0, s68, 32768
    s_mul_i32 s76, s1, 229376
    s_add_u32 s76, s76, 128
    buffer_load_dwordx4 v253, s[36:39], s76 offen lds
    v_mul_f32 v216, s75, v216
    v_mul_f32 v217, s75, v217
    v_mul_f32 v218, s75, v218
    v_mul_f32 v219, s75, v219
    v_mul_f32 v220, s75, v220
    v_mul_f32 v221, s75, v221
    ds_read_b64_tr_b16 v[16:17], v2 offset:20480
    ds_read_b64_tr_b16 v[18:19], v2 offset:20992
    v_mfma_f32_32x32x16_bf16 v[68:83], v[12:15], v[156:159], v[68:83]
    s_setprio 2
    buffer_load_dwordx4 v252, s[40:43], s76 offen offset:1024 lds
    v_mul_f32 v222, s75, v222
    v_mul_f32 v223, s75, v223
    v_exp_f32 v216, v216
    v_exp_f32 v217, v217
    ds_read_b64_tr_b16 v[12:13], v2 offset:24576
    ds_read_b64_tr_b16 v[14:15], v2 offset:25088
    s_waitcnt lgkmcnt(4)
    v_mfma_f32_32x32x16_bf16 v[68:83], v[8:11], v[152:155], v[68:83]
    s_add_u32 m0, s68, 49152
    s_mul_i32 s76, s12, 229376
    s_add_u32 s76, s76, 128
    buffer_load_dwordx4 v253, s[36:39], s76 offen lds
    v_mov_b32 v3, 0
    s_waitcnt vmcnt(5)
    v_dot2_f32_bf16 v3, v36, v44, v3
    v_dot2_f32_bf16 v3, v37, v45, v3
    v_exp_f32 v218, v218
    v_exp_f32 v219, v219
    ds_read_b64_tr_b16 v[8:9], v2 offset:28672
    ds_read_b64_tr_b16 v[10:11], v2 offset:29184
    s_waitcnt lgkmcnt(4)
    v_mfma_f32_32x32x16_bf16 v[68:83], v[16:19], v[148:151], v[68:83]
    s_setprio 1
    buffer_load_dwordx4 v252, s[40:43], s76 offen offset:1024 lds
    v_dot2_f32_bf16 v3, v38, v46, v3
    v_dot2_f32_bf16 v3, v39, v47, v3
    s_waitcnt vmcnt(5)
    v_dot2_f32_bf16 v3, v40, v48, v3
    v_exp_f32 v220, v220
    v_exp_f32 v221, v221
    ds_read_b64_tr_b16 v[16:17], v2 offset:17408
    ds_read_b64_tr_b16 v[18:19], v2 offset:17920
    s_waitcnt lgkmcnt(4)
    v_mfma_f32_32x32x16_bf16 v[68:83], v[12:15], v[144:147], v[68:83]
    s_add_u32 m0, s68, 81920
    s_mul_i32 s76, s13, 229376
    s_add_u32 s76, s76, 128
    buffer_load_dwordx4 v253, s[36:39], s76 offen lds
    v_dot2_f32_bf16 v3, v41, v49, v3
    v_dot2_f32_bf16 v3, v42, v50, v3
    v_exp_f32 v222, v222
    v_exp_f32 v223, v223
    ds_read_b64_tr_b16 v[12:13], v2 offset:21504
    ds_read_b64_tr_b16 v[14:15], v2 offset:22016
    s_waitcnt lgkmcnt(4)
    v_mfma_f32_32x32x16_bf16 v[68:83], v[8:11], v[140:143], v[68:83]
    s_setprio 0
    buffer_load_dwordx4 v252, s[40:43], s76 offen offset:1024 lds
    v_dot2_f32_bf16 v3, v43, v51, v3
    s_nop 2
    v_add_f32 v3, v3, v3 row_shr:1 row_mask:0xf bank_mask:0xf bound_ctrl:0
    v_add_f32 v216, 1.0, v216
    v_add_f32 v217, 1.0, v217
    v_add_f32 v218, 1.0, v218
    v_add_f32 v219, 1.0, v219
    v_add_f32 v220, 1.0, v220
    ds_read_b64_tr_b16 v[8:9], v2 offset:25600
    ds_read_b64_tr_b16 v[10:11], v2 offset:26112
    s_waitcnt lgkmcnt(4)
    v_mfma_f32_32x32x16_bf16 v[68:83], v[16:19], v[132:135], v[68:83]
    v_add_f32 v3, v3, v3 row_shr:2 row_mask:0xf bank_mask:0xf bound_ctrl:0
    s_nop 1
    v_add_f32 v3, v3, v3 row_shr:4 row_mask:0xf bank_mask:0xf bound_ctrl:0
    s_nop 1
    v_add_f32 v3, v3, v3 row_shr:8 row_mask:0xf bank_mask:0xf bound_ctrl:0
    v_add_f32 v221, 1.0, v221
    v_add_f32 v222, 1.0, v222
    v_add_f32 v223, 1.0, v223
    v_rcp_f32 v216, v216
    ds_read_b64_tr_b16 v[16:17], v2 offset:29696
    ds_read_b64_tr_b16 v[18:19], v2 offset:30208
    s_waitcnt lgkmcnt(4)
    v_mfma_f32_32x32x16_bf16 v[68:83], v[12:15], v[124:127], v[68:83]
    v_add_f32 v3, v3, v3 row_bcast:15 row_mask:0xa bank_mask:0xf
    v_mul_f32 v3, s75, v3
    v_rcp_f32 v217, v217
    v_rcp_f32 v218, v218
    ds_read_b64_tr_b16 v[12:13], v7
    ds_read_b64_tr_b16 v[14:15], v7 offset:512
    s_waitcnt lgkmcnt(4)
    v_mfma_f32_32x32x16_bf16 v[68:83], v[8:11], v[120:123], v[68:83]
    s_add_u32 m0, s68, 98304
    s_mul_i32 s76, s18, 229376
    s_add_u32 s76, s76, 128
    buffer_load_dwordx4 v253, s[36:39], s76 offen lds
    v_exp_f32 v3, v3
    s_nop 0
    v_add_f32 v3, 1.0, v3
    v_rcp_f32 v219, v219
    v_rcp_f32 v220, v220
    ds_read_b64_tr_b16 v[8:9], v7 offset:4096
    ds_read_b64_tr_b16 v[10:11], v7 offset:4608
    s_waitcnt lgkmcnt(4)
    v_mfma_f32_32x32x16_bf16 v[68:83], v[16:19], v[116:119], v[68:83]
    s_setprio 2
    buffer_load_dwordx4 v252, s[40:43], s76 offen offset:1024 lds
    v_rcp_f32 v3, v3
    v_rcp_f32 v221, v221
    v_rcp_f32 v222, v222
    ds_read_b64_tr_b16 v[16:17], v7 offset:8192
    ds_read_b64_tr_b16 v[18:19], v7 offset:8704
    s_waitcnt lgkmcnt(4)
    v_mfma_f32_32x32x16_bf16 v[68:83], v[12:15], v[112:115], v[68:83]
    v_rcp_f32 v223, v223
    v_mul_f32 v224, v216, v224
    v_mul_f32 v225, v217, v225
    v_mul_f32 v226, v218, v226
    ds_read_b64_tr_b16 v[12:13], v7 offset:12288
    ds_read_b64_tr_b16 v[14:15], v7 offset:12800
    s_waitcnt lgkmcnt(4)
    v_mfma_f32_32x32x16_bf16 v[68:83], v[8:11], v[108:111], v[68:83]
    s_setprio 1
    v_mul_f32 v227, v219, v227
    v_mul_f32 v228, v220, v228
    v_mul_f32 v229, v221, v229
    v_mul_f32 v230, v222, v230
    v_mul_f32 v231, v223, v231
    v_cvt_pk_bf16_f32 v216, v224, v225
    ds_read_b64_tr_b16 v[8:9], v7 offset:1024
    ds_read_b64_tr_b16 v[10:11], v7 offset:1536
    s_waitcnt lgkmcnt(4)
    v_mfma_f32_32x32x16_bf16 v[68:83], v[16:19], v[104:107], v[68:83]
    v_cvt_pk_bf16_f32 v217, v226, v227
    v_cvt_pk_bf16_f32 v218, v228, v229
    v_cvt_pk_bf16_f32 v219, v230, v231
    s_add_u32 s78, s79, 8192
    buffer_store_dwordx4 v[216:219], v246, s[52:55], s78 offen sc1
    ds_read_b64_tr_b16 v[16:17], v7 offset:5120
    ds_read_b64_tr_b16 v[18:19], v7 offset:5632
    s_waitcnt lgkmcnt(4)
    v_mfma_f32_32x32x16_bf16 v[68:83], v[12:15], v[100:103], v[68:83]
    s_setprio 0
    v_bfe_u32 v2, v255, 5, 1
    v_lshlrev_b32 v4, 2, v2
    s_mov_b32 exec_lo, 0x80000000
    s_mov_b32 exec_hi, 0x80000000
    buffer_store_dword v3, v4, s[52:55], s93 offen sc1
    s_mov_b64 exec, -1
    ds_read_b64_tr_b16 v[12:13], v7 offset:9216
    ds_read_b64_tr_b16 v[14:15], v7 offset:9728
    s_waitcnt lgkmcnt(4)
    v_mfma_f32_32x32x16_bf16 v[68:83], v[8:11], v[96:99], v[68:83]
    ds_read_b64_tr_b16 v[8:9], v7 offset:13312
    ds_read_b64_tr_b16 v[10:11], v7 offset:13824
    s_waitcnt lgkmcnt(4)
    v_mfma_f32_32x32x16_bf16 v[68:83], v[16:19], v[92:95], v[68:83]
    s_waitcnt lgkmcnt(0)
    s_cmp_lg_u32 s60, 0
    s_cbranch_scc1 LB_back_4
    s_waitcnt vmcnt(11)
    v_cmp_ne_u32 vcc, 0, v0
    s_nop 0
    s_cmp_eq_u64 vcc, -1
    s_cbranch_scc0 LB_slow_3
LB_back_4:
    s_barrier
    s_setprio 3
    s_waitcnt vmcnt(0)
    ds_read_b64_tr_b16 v[0:1], v244 offset:16384
    ds_read_b64_tr_b16 v[2:3], v244 offset:16896
    v_mfma_f32_32x32x16_bf16 v[68:83], v[12:15], v[88:91], v[68:83]
    s_add_u32 m0, s68, 65536
    s_mul_i32 s76, s19, 229376
    s_add_u32 s76, s76, 128
    buffer_load_dwordx4 v253, s[36:39], s76 offen lds
    ds_read_b64_tr_b16 v[4:5], v243 offset:16384
    ds_read_b64_tr_b16 v[6:7], v243 offset:16896
    v_mfma_f32_32x32x16_bf16 v[68:83], v[8:11], v[84:87], v[68:83]
    s_setprio 2
    buffer_load_dwordx4 v252, s[40:43], s76 offen offset:1024 lds
    ds_read_b64_tr_b16 v[8:9], v244 offset:20480
    ds_read_b64_tr_b16 v[10:11], v244 offset:20992
    s_waitcnt lgkmcnt(4)
    v_mfma_f32_32x32x16_bf16 v[12:27], v[0:3], v[236:239], 0
    ds_read_b64_tr_b16 v[0:1], v243 offset:20480
    ds_read_b64_tr_b16 v[2:3], v243 offset:20992
    s_waitcnt lgkmcnt(4)
    v_mfma_f32_32x32x16_bf16 v[216:231], v[4:7], v[236:239], 0
    s_setprio 1
    s_nop 0
    v_cvt_pk_bf16_f32 v68, v68, v69
    v_cvt_pk_bf16_f32 v69, v70, v71
    v_cvt_pk_bf16_f32 v70, v72, v73
    v_cvt_pk_bf16_f32 v71, v74, v75
    ds_read_b64_tr_b16 v[4:5], v244 offset:24576
    ds_read_b64_tr_b16 v[6:7], v244 offset:25088
    s_waitcnt lgkmcnt(4)
    v_mfma_f32_32x32x16_bf16 v[12:27], v[8:11], v[232:235], v[12:27]
    v_cvt_pk_bf16_f32 v72, v76, v77
    v_cvt_pk_bf16_f32 v73, v78, v79
    v_cvt_pk_bf16_f32 v74, v80, v81
    ds_read_b64_tr_b16 v[8:9], v243 offset:24576
    ds_read_b64_tr_b16 v[10:11], v243 offset:25088
    s_waitcnt lgkmcnt(4)
    v_mfma_f32_32x32x16_bf16 v[216:231], v[0:3], v[232:235], v[216:231]
    s_setprio 0
    v_cvt_pk_bf16_f32 v75, v82, v83
    v_mfma_f32_32x32x16_bf16 v[28:43], v[136:139], v[68:71], 0
    ds_read_b64_tr_b16 v[0:1], v244 offset:28672
    ds_read_b64_tr_b16 v[2:3], v244 offset:29184
    s_waitcnt lgkmcnt(4)
    v_mfma_f32_32x32x16_bf16 v[12:27], v[4:7], v[212:215], v[12:27]
    v_mfma_f32_32x32x16_bf16 v[28:43], v[128:131], v[72:75], v[28:43]
    s_nop 11
    v_max3_f32 v4, v28, v29, v30
    v_min3_f32 v5, v28, v29, v30
    ds_read_b64_tr_b16 v[44:45], v243 offset:28672
    ds_read_b64_tr_b16 v[46:47], v243 offset:29184
    s_waitcnt lgkmcnt(4)
    v_mfma_f32_32x32x16_bf16 v[216:231], v[8:11], v[212:215], v[216:231]
    v_max3_f32 v4, v4, v31, v32
    v_min3_f32 v5, v5, v31, v32
    v_max3_f32 v4, v4, v33, v34
    s_waitcnt lgkmcnt(0)
    s_barrier
    s_setprio 3
    v_mov_b32 v6, 1
    s_cmp_lg_u32 s60, 0
    s_cbranch_scc1 LB_nosig_7
    s_mov_b64 exec, 1
    buffer_atomic_add v6, v245, s[52:55], s84 offen
    s_mov_b64 exec, -1
LB_nosig_7:
    ds_read_b64_tr_b16 v[8:9], v244 offset:32768
    ds_read_b64_tr_b16 v[10:11], v244 offset:33280
    v_mfma_f32_32x32x16_bf16 v[12:27], v[0:3], v[208:211], v[12:27]
    s_add_u32 m0, s68, 114688
    s_mul_i32 s76, s22, 229376
    s_add_u32 s76, s76, 128
    buffer_load_dwordx4 v253, s[36:39], s76 offen lds
    v_min3_f32 v5, v5, v33, v34
    v_max3_f32 v4, v4, v35, v36
    v_min3_f32 v5, v5, v35, v36
    ds_read_b64_tr_b16 v[0:1], v243 offset:32768
    ds_read_b64_tr_b16 v[2:3], v243 offset:33280
    v_mfma_f32_32x32x16_bf16 v[216:231], v[44:47], v[208:211], v[216:231]
    s_setprio 2
    buffer_load_dwordx4 v252, s[40:43], s76 offen offset:1024 lds
    v_max3_f32 v4, v4, v37, v38
    v_min3_f32 v5, v5, v37, v38
    v_max3_f32 v4, v4, v39, v40
    v_min3_f32 v5, v5, v39, v40
    ds_read_b64_tr_b16 v[44:45], v244 offset:36864
    ds_read_b64_tr_b16 v[46:47], v244 offset:37376
    s_waitcnt lgkmcnt(4)
    v_mfma_f32_32x32x16_bf16 v[12:27], v[8:11], v[204:207], v[12:27]
    s_add_u32 m0, s68, 131072
    s_mul_i32 s76, s23, 229376
    s_add_u32 s76, s76, 128
    buffer_load_dwordx4 v253, s[36:39], s76 offen lds
    v_max3_f32 v4, v4, v41, v42
    v_min3_f32 v5, v5, v41, v42
    v_max_f32 v4, v4, v43
    ds_read_b64_tr_b16 v[8:9], v243 offset:36864
    ds_read_b64_tr_b16 v[10:11], v243 offset:37376
    s_waitcnt lgkmcnt(4)
    v_mfma_f32_32x32x16_bf16 v[216:231], v[0:3], v[204:207], v[216:231]
    s_setprio 1
    buffer_load_dwordx4 v252, s[40:43], s76 offen offset:1024 lds
    v_min_f32 v5, v5, v43
    v_sub_f32 v68, v28, v4
    v_sub_f32 v28, v5, v28
    v_sub_f32 v69, v29, v4
    v_sub_f32 v29, v5, v29
    v_exp_f32 v68, v68
    ds_read_b64_tr_b16 v[0:1], v244 offset:40960
    ds_read_b64_tr_b16 v[2:3], v244 offset:41472
    s_waitcnt lgkmcnt(4)
    v_mfma_f32_32x32x16_bf16 v[12:27], v[44:47], v[200:203], v[12:27]
    v_exp_f32 v28, v28
    ds_read_b64_tr_b16 v[44:45], v243 offset:40960
    ds_read_b64_tr_b16 v[46:47], v243 offset:41472
    s_waitcnt lgkmcnt(4)
    v_mfma_f32_32x32x16_bf16 v[216:231], v[8:11], v[200:203], v[216:231]
    s_setprio 0
    v_sub_f32 v70, v30, v4
    v_sub_f32 v30, v5, v30
    v_exp_f32 v69, v69
    ds_read_b64_tr_b16 v[8:9], v244 offset:45056
    ds_read_b64_tr_b16 v[10:11], v244 offset:45568
    s_waitcnt lgkmcnt(4)
    v_mfma_f32_32x32x16_bf16 v[12:27], v[0:3], v[196:199], v[12:27]
    v_exp_f32 v29, v29
    v_sub_f32 v71, v31, v4
    v_sub_f32 v31, v5, v31
    ds_read_b64_tr_b16 v[0:1], v243 offset:45056
    ds_read_b64_tr_b16 v[2:3], v243 offset:45568
    s_waitcnt lgkmcnt(4)
    v_mfma_f32_32x32x16_bf16 v[216:231], v[44:47], v[196:199], v[216:231]
    v_exp_f32 v70, v70
    v_exp_f32 v30, v30
    s_waitcnt lgkmcnt(0)
    s_barrier
    s_setprio 3
    ds_read_b64_tr_b16 v[44:45], v244 offset:49152
    ds_read_b64_tr_b16 v[46:47], v244 offset:49664
    v_mfma_f32_32x32x16_bf16 v[12:27], v[8:11], v[192:195], v[12:27]
    s_add_u32 m0, s68, 147456
    s_add_u32 s76, s6, s71
    buffer_load_dwordx4 v251, s[44:47], s76 offen lds
    v_sub_f32 v72, v32, v4
    v_sub_f32 v32, v5, v32
    v_exp_f32 v71, v71
    ds_read_b64_tr_b16 v[8:9], v243 offset:49152
    ds_read_b64_tr_b16 v[10:11], v243 offset:49664
    v_mfma_f32_32x32x16_bf16 v[216:231], v[0:3], v[192:195], v[216:231]
    s_setprio 2
    buffer_load_dwordx4 v250, s[44:47], s76 offen offset:1024 lds
    v_exp_f32 v31, v31
    v_sub_f32 v73, v33, v4
    v_sub_f32 v33, v5, v33
    ds_read_b64_tr_b16 v[0:1], v244 offset:53248
    ds_read_b64_tr_b16 v[2:3], v244 offset:53760
    s_waitcnt lgkmcnt(4)
    v_mfma_f32_32x32x16_bf16 v[12:27], v[44:47], v[188:191], v[12:27]
    s_add_u32 m0, s68, 0
    s_add_u32 s76, s7, s71
    buffer_load_dwordx4 v251, s[44:47], s76 offen lds
    v_exp_f32 v72, v72
    v_exp_f32 v32, v32
    ds_read_b64_tr_b16 v[44:45], v243 offset:53248
    ds_read_b64_tr_b16 v[46:47], v243 offset:53760
    s_waitcnt lgkmcnt(4)
    v_mfma_f32_32x32x16_bf16 v[216:231], v[8:11], v[188:191], v[216:231]
    s_setprio 1
    buffer_load_dwordx4 v250, s[44:47], s76 offen offset:1024 lds
    v_sub_f32 v74, v34, v4
    v_sub_f32 v34, v5, v34
    v_exp_f32 v73, v73
    ds_read_b64_tr_b16 v[8:9], v244 offset:57344
    ds_read_b64_tr_b16 v[10:11], v244 offset:57856
    s_waitcnt lgkmcnt(4)
    v_mfma_f32_32x32x16_bf16 v[12:27], v[0:3], v[184:187], v[12:27]
    v_exp_f32 v33, v33
    v_sub_f32 v75, v35, v4
    v_sub_f32 v35, v5, v35
    ds_read_b64_tr_b16 v[0:1], v243 offset:57344
    ds_read_b64_tr_b16 v[2:3], v243 offset:57856
    s_waitcnt lgkmcnt(4)
    v_mfma_f32_32x32x16_bf16 v[216:231], v[44:47], v[184:187], v[216:231]
    s_setprio 0
    v_exp_f32 v74, v74
    v_exp_f32 v34, v34
    ds_read_b64_tr_b16 v[44:45], v244 offset:61440
    ds_read_b64_tr_b16 v[46:47], v244 offset:61952
    s_waitcnt lgkmcnt(4)
    v_mfma_f32_32x32x16_bf16 v[12:27], v[8:11], v[180:183], v[12:27]
    v_sub_f32 v76, v36, v4
    v_sub_f32 v36, v5, v36
    v_exp_f32 v75, v75
    ds_read_b64_tr_b16 v[8:9], v243 offset:61440
    ds_read_b64_tr_b16 v[10:11], v243 offset:61952
    s_waitcnt lgkmcnt(4)
    v_mfma_f32_32x32x16_bf16 v[216:231], v[0:3], v[180:183], v[216:231]
    v_exp_f32 v35, v35
    v_sub_f32 v77, v37, v4
    v_sub_f32 v37, v5, v37
    ds_read_b64_tr_b16 v[0:1], v242 offset:16384
    ds_read_b64_tr_b16 v[2:3], v242 offset:16896
    s_waitcnt lgkmcnt(4)
    v_mfma_f32_32x32x16_bf16 v[12:27], v[44:47], v[176:179], v[12:27]
    s_add_u32 m0, s68, 16384
    s_add_u32 s76, s26, s71
    buffer_load_dwordx4 v251, s[44:47], s76 offen lds
    v_exp_f32 v76, v76
    v_exp_f32 v36, v36
    ds_read_b64_tr_b16 v[44:45], v241 offset:16384
    ds_read_b64_tr_b16 v[46:47], v241 offset:16896
    s_waitcnt lgkmcnt(4)
    v_mfma_f32_32x32x16_bf16 v[216:231], v[8:11], v[176:179], v[216:231]
    s_setprio 2
    buffer_load_dwordx4 v250, s[44:47], s76 offen offset:1024 lds
    v_sub_f32 v78, v38, v4
    v_sub_f32 v38, v5, v38
    v_exp_f32 v77, v77
    ds_read_b64_tr_b16 v[8:9], v242 offset:20480
    ds_read_b64_tr_b16 v[10:11], v242 offset:20992
    s_waitcnt lgkmcnt(4)
    v_mfma_f32_32x32x16_bf16 v[12:27], v[0:3], v[172:175], v[12:27]
    s_add_u32 m0, s68, 32768
    s_add_u32 s76, s27, s71
    buffer_load_dwordx4 v251, s[44:47], s76 offen lds
    v_exp_f32 v37, v37
    v_sub_f32 v79, v39, v4
    ds_read_b64_tr_b16 v[0:1], v241 offset:20480
    ds_read_b64_tr_b16 v[2:3], v241 offset:20992
    s_waitcnt lgkmcnt(4)
    v_mfma_f32_32x32x16_bf16 v[216:231], v[44:47], v[172:175], v[216:231]
    s_setprio 1
    buffer_load_dwordx4 v250, s[44:47], s76 offen offset:1024 lds
    v_sub_f32 v39, v5, v39
    v_exp_f32 v78, v78
    v_exp_f32 v38, v38
    ds_read_b64_tr_b16 v[44:45], v242 offset:24576
    ds_read_b64_tr_b16 v[46:47], v242 offset:25088
    s_waitcnt lgkmcnt(4)
    v_mfma_f32_32x32x16_bf16 v[12:27], v[8:11], v[164:167], v[12:27]
    v_sub_f32 v80, v40, v4
    v_sub_f32 v40, v5, v40
    v_exp_f32 v79, v79
    ds_read_b64_tr_b16 v[8:9], v241 offset:24576
    ds_read_b64_tr_b16 v[10:11], v241 offset:25088
    s_waitcnt lgkmcnt(4)
    v_mfma_f32_32x32x16_bf16 v[216:231], v[0:3], v[164:167], v[216:231]
    s_setprio 0
    v_exp_f32 v39, v39
    v_sub_f32 v81, v41, v4
    ds_read_b64_tr_b16 v[0:1], v242 offset:28672
    ds_read_b64_tr_b16 v[2:3], v242 offset:29184
    s_waitcnt lgkmcnt(4)
    v_mfma_f32_32x32x16_bf16 v[12:27], v[44:47], v[160:163], v[12:27]
    v_sub_f32 v41, v5, v41
    v_exp_f32 v80, v80
    v_exp_f32 v40, v40
    ds_read_b64_tr_b16 v[44:45], v241 offset:28672
    ds_read_b64_tr_b16 v[46:47], v241 offset:29184
    s_waitcnt lgkmcnt(4)
    v_mfma_f32_32x32x16_bf16 v[216:231], v[8:11], v[160:163], v[216:231]
    v_sub_f32 v82, v42, v4
    v_sub_f32 v42, v5, v42
    v_exp_f32 v81, v81
    s_waitcnt lgkmcnt(0)
    s_barrier
    s_setprio 3
    s_cmp_lg_u32 s60, 0
    s_cbranch_scc1 LB_np_15
    buffer_load_dword v6, v245, s[52:55], s85 offen sc1
LB_np_15:
    ds_read_b64_tr_b16 v[8:9], v242 offset:32768
    ds_read_b64_tr_b16 v[10:11], v242 offset:33280
    v_mfma_f32_32x32x16_bf16 v[12:27], v[0:3], v[156:159], v[12:27]
    s_add_u32 m0, s68, 49152
    s_add_u32 s76, s6, s98
    buffer_load_dwordx4 v251, s[44:47], s76 offen lds
    v_exp_f32 v41, v41
    v_sub_f32 v83, v43, v4
    ds_read_b64_tr_b16 v[0:1], v241 offset:32768
    ds_read_b64_tr_b16 v[2:3], v241 offset:33280
    v_mfma_f32_32x32x16_bf16 v[216:231], v[44:47], v[156:159], v[216:231]
    s_setprio 2
    buffer_load_dwordx4 v250, s[44:47], s76 offen offset:1024 lds
    v_sub_f32 v43, v5, v43
    v_exp_f32 v82, v82
    v_exp_f32 v42, v42
    ds_read_b64_tr_b16 v[44:45], v242 offset:36864
    ds_read_b64_tr_b16 v[46:47], v242 offset:37376
    s_waitcnt lgkmcnt(4)
    v_mfma_f32_32x32x16_bf16 v[12:27], v[8:11], v[152:155], v[12:27]
    s_add_u32 m0, s68, 81920
    s_add_u32 s76, s7, s98
    buffer_load_dwordx4 v251, s[44:47], s76 offen lds
    v_exp_f32 v83, v83
    ds_read_b64_tr_b16 v[8:9], v241 offset:36864
    ds_read_b64_tr_b16 v[10:11], v241 offset:37376
    s_waitcnt lgkmcnt(4)
    v_mfma_f32_32x32x16_bf16 v[216:231], v[0:3], v[152:155], v[216:231]
    s_setprio 1
    buffer_load_dwordx4 v250, s[44:47], s76 offen offset:1024 lds
    v_exp_f32 v43, v43
    v_cvt_pk_bf16_f32 v68, v68, v69
    v_cvt_pk_bf16_f32 v69, v70, v71
    ds_read_b64_tr_b16 v[0:1], v242 offset:40960
    ds_read_b64_tr_b16 v[2:3], v242 offset:41472
    s_waitcnt lgkmcnt(4)
    v_mfma_f32_32x32x16_bf16 v[12:27], v[44:47], v[148:151], v[12:27]
    v_cvt_pk_bf16_f32 v70, v72, v73
    v_cvt_pk_bf16_f32 v71, v74, v75
    v_cvt_pk_bf16_f32 v72, v76, v77
    ds_read_b64_tr_b16 v[44:45], v241 offset:40960
    ds_read_b64_tr_b16 v[46:47], v241 offset:41472
    s_waitcnt lgkmcnt(4)
    v_mfma_f32_32x32x16_bf16 v[216:231], v[8:11], v[148:151], v[216:231]
    s_setprio 0
    v_cvt_pk_bf16_f32 v73, v78, v79
    v_cvt_pk_bf16_f32 v74, v80, v81
    v_cvt_pk_bf16_f32 v75, v82, v83
    ds_read_b64_tr_b16 v[8:9], v242 offset:45056
    ds_read_b64_tr_b16 v[10:11], v242 offset:45568
    s_waitcnt lgkmcnt(4)
    v_mfma_f32_32x32x16_bf16 v[12:27], v[0:3], v[144:147], v[12:27]
    v_cvt_pk_bf16_f32 v76, v28, v29
    v_cvt_pk_bf16_f32 v77, v30, v31
    v_cvt_pk_bf16_f32 v78, v32, v33
    v_cvt_pk_bf16_f32 v79, v34, v35
    ds_read_b64_tr_b16 v[0:1], v241 offset:45056
    ds_read_b64_tr_b16 v[2:3], v241 offset:45568
    s_waitcnt lgkmcnt(4)
    v_mfma_f32_32x32x16_bf16 v[216:231], v[44:47], v[144:147], v[216:231]
    v_cvt_pk_bf16_f32 v80, v36, v37
    v_cvt_pk_bf16_f32 v81, v38, v39
    v_cvt_pk_bf16_f32 v82, v40, v41
    s_waitcnt vmcnt(16) lgkmcnt(0)
    s_cmp_lg_u32 s60, 0
    s_cbranch_scc1 LB_back_14
    s_waitcnt vmcnt(4)
    v_readfirstlane_b32 s87, v6
    s_nop 0
    s_cmp_eq_u32 s87, 8
    s_cbranch_scc0 LB_slow_13
LB_back_14:
    s_barrier
    s_setprio 3
    ds_read_b64_tr_b16 v[28:29], v242
    ds_read_b64_tr_b16 v[30:31], v242 offset:512
    v_mfma_f32_32x32x16_bf16 v[12:27], v[8:11], v[140:143], v[12:27]
    s_add_u32 m0, s68, 98304
    s_add_u32 s76, s26, s98
    buffer_load_dwordx4 v251, s[44:47], s76 offen lds
    v_cvt_pk_bf16_f32 v83, v42, v43
    v_permlane32_swap_b32 v68, v72
    v_permlane32_swap_b32 v69, v73
    v_permlane32_swap_b32 v70, v74
    s_lshr_b32 s78, s6, 1
    s_add_u32 s78, s78, s81
    buffer_load_dwordx4 v[8:11], v246, s[52:55], s78 offen sc1
    buffer_load_dwordx4 v[32:35], v246, s[52:55], s78 offen offset:1024 sc1
    ds_read_b64_tr_b16 v[36:37], v241
    ds_read_b64_tr_b16 v[38:39], v241 offset:512
    v_mfma_f32_32x32x16_bf16 v[216:231], v[0:3], v[140:143], v[216:231]
    s_setprio 2
    buffer_load_dwordx4 v250, s[44:47], s76 offen offset:1024 lds
    v_permlane32_swap_b32 v71, v75
    v_permlane32_swap_b32 v76, v80
    v_permlane32_swap_b32 v77, v81
    v_permlane32_swap_b32 v78, v82
    v_permlane32_swap_b32 v79, v83
    ds_read_b64_tr_b16 v[0:1], v242 offset:4096
    ds_read_b64_tr_b16 v[2:3], v242 offset:4608
    s_waitcnt lgkmcnt(4)
    v_mfma_f32_32x32x16_bf16 v[12:27], v[28:31], v[132:135], v[12:27]
    ds_read_b64_tr_b16 v[28:29], v241 offset:4096
    ds_read_b64_tr_b16 v[30:31], v241 offset:4608
    s_waitcnt lgkmcnt(4)
    v_mfma_f32_32x32x16_bf16 v[216:231], v[36:39], v[132:135], v[216:231]
    s_setprio 1
    ds_read_b64_tr_b16 v[36:37], v242 offset:8192
    ds_read_b64_tr_b16 v[38:39], v242 offset:8704
    s_waitcnt lgkmcnt(4)
    v_mfma_f32_32x32x16_bf16 v[12:27], v[0:3], v[124:127], v[12:27]
    ds_read_b64_tr_b16 v[0:1], v241 offset:8192
    ds_read_b64_tr_b16 v[2:3], v241 offset:8704
    s_waitcnt lgkmcnt(4)
    v_mfma_f32_32x32x16_bf16 v[216:231], v[28:31], v[124:127], v[216:231]
    s_setprio 0
    s_lshr_b32 s78, s7, 1
    s_add_u32 s78, s78, s81
    buffer_load_dwordx4 v[28:31], v246, s[52:55], s78 offen sc1
    buffer_load_dwordx4 v[40:43], v246, s[52:55], s78 offen offset:1024 sc1
    ds_read_b64_tr_b16 v[44:45], v242 offset:12288
    ds_read_b64_tr_b16 v[46:47], v242 offset:12800
    s_waitcnt lgkmcnt(4)
    v_mfma_f32_32x32x16_bf16 v[12:27], v[36:39], v[120:123], v[12:27]
    ds_read_b64_tr_b16 v[36:37], v241 offset:12288
    ds_read_b64_tr_b16 v[38:39], v241 offset:12800
    s_waitcnt lgkmcnt(4)
    v_mfma_f32_32x32x16_bf16 v[216:231], v[0:3], v[120:123], v[216:231]
    s_waitcnt vmcnt(18) lgkmcnt(0)
    s_barrier
    s_setprio 3
    ds_read_b64_tr_b16 v[0:1], v242 offset:49152
    ds_read_b64_tr_b16 v[2:3], v242 offset:49664
    v_mfma_f32_32x32x16_bf16 v[12:27], v[44:47], v[116:119], v[12:27]
    s_add_u32 m0, s68, 65536
    s_add_u32 s76, s27, s98
    buffer_load_dwordx4 v251, s[44:47], s76 offen lds
    ds_read_b64_tr_b16 v[4:5], v241 offset:49152
    s_waitcnt vmcnt(7)
    ds_read_b64_tr_b16 v[6:7], v241 offset:49664
    v_mfma_f32_32x32x16_bf16 v[216:231], v[36:39], v[116:119], v[216:231]
    s_setprio 2
    buffer_load_dwordx4 v250, s[44:47], s76 offen offset:1024 lds
    ds_read_b64_tr_b16 v[36:37], v242 offset:53248
    ds_read_b64_tr_b16 v[38:39], v242 offset:53760
    s_waitcnt lgkmcnt(4)
    v_mfma_f32_32x32x16_bf16 v[12:27], v[0:3], v[112:115], v[12:27]
    s_lshr_b32 s78, s26, 1
    s_add_u32 s78, s78, s81
    buffer_load_dwordx4 v[0:3], v246, s[52:55], s78 offen sc1
    buffer_load_dwordx4 v[44:47], v246, s[52:55], s78 offen offset:1024 sc1
    ds_read_b64_tr_b16 v[48:49], v241 offset:53248
    ds_read_b64_tr_b16 v[50:51], v241 offset:53760
    s_waitcnt lgkmcnt(4)
    v_mfma_f32_32x32x16_bf16 v[216:231], v[4:7], v[112:115], v[216:231]
    s_setprio 1
    ds_read_b64_tr_b16 v[4:5], v242 offset:57344
    ds_read_b64_tr_b16 v[6:7], v242 offset:57856
    s_waitcnt lgkmcnt(4)
    v_mfma_f32_32x32x16_bf16 v[12:27], v[36:39], v[108:111], v[12:27]
    ds_read_b64_tr_b16 v[36:37], v241 offset:57344
    ds_read_b64_tr_b16 v[38:39], v241 offset:57856
    s_waitcnt lgkmcnt(4)
    v_mfma_f32_32x32x16_bf16 v[216:231], v[48:51], v[108:111], v[216:231]
    s_setprio 0
    ds_read_b64_tr_b16 v[48:49], v242 offset:61440
    ds_read_b64_tr_b16 v[50:51], v242 offset:61952
    s_waitcnt lgkmcnt(4)
    v_mfma_f32_32x32x16_bf16 v[12:27], v[4:7], v[104:107], v[12:27]
    ds_read_b64_tr_b16 v[4:5], v241 offset:61440
    ds_read_b64_tr_b16 v[6:7], v241 offset:61952
    s_waitcnt lgkmcnt(4)
    v_mfma_f32_32x32x16_bf16 v[216:231], v[36:39], v[104:107], v[216:231]
    s_lshr_b32 s78, s27, 1
    s_add_u32 s78, s78, s81
    buffer_load_dwordx4 v[36:39], v246, s[52:55], s78 offen sc1
    buffer_load_dwordx4 v[52:55], v246, s[52:55], s78 offen offset:1024 sc1
    ds_read_b64_tr_b16 v[56:57], v240
    ds_read_b64_tr_b16 v[58:59], v240 offset:512
    s_waitcnt lgkmcnt(4)
    v_mfma_f32_32x32x16_bf16 v[12:27], v[48:51], v[100:103], v[12:27]
    ds_read_b64_tr_b16 v[48:49], v171
    ds_read_b64_tr_b16 v[50:51], v171 offset:512
    s_waitcnt lgkmcnt(4)
    v_mfma_f32_32x32x16_bf16 v[216:231], v[4:7], v[100:103], v[216:231]
    s_setprio 2
    ds_read_b64_tr_b16 v[4:5], v240 offset:4096
    ds_read_b64_tr_b16 v[6:7], v240 offset:4608
    s_waitcnt lgkmcnt(4)
    v_mfma_f32_32x32x16_bf16 v[12:27], v[56:59], v[96:99], v[12:27]
    v_and_b32 v56, 31, v255
    v_min_u32 v56, 16, v56
    v_and_b32 v57, 27, v255
    v_cmp_eq_u32 vcc, 17, v57
    s_nop 1
    v_cndmask_b32 v56, v56, v57, vcc
    s_mul_i32 s78, s62, 36
    v_add_u32 v56, s78, v56
    v_bfe_u32 v58, v255, 5, 1
    v_lshlrev_b32 v253, 9, v58
    v_bfe_u32 v58, v255, 2, 2
    ds_read_b64_tr_b16 v[60:61], v171 offset:4096
    ds_read_b64_tr_b16 v[62:63], v171 offset:4608
    s_waitcnt lgkmcnt(4)
    v_mfma_f32_32x32x16_bf16 v[216:231], v[48:51], v[96:99], v[216:231]
    s_setprio 1
    v_lshl_add_u32 v253, v58, 7, v253
    v_bfe_u32 v58, v255, 3, 1
    s_lshl_b32 s78, s65, 1
    s_add_u32 s78, s78, s62
    s_lshl_b32 s78, s78, 7
    s_add_u32 s78, s78, 9568256
    v_bfe_u32 v48, v255, 0, 5
    v_lshlrev_b32 v49, 2, v48
    buffer_load_dword v252, v49, s[52:55], s78 offen sc1
    ds_read_b64_tr_b16 v[48:49], v240 offset:8192
    ds_read_b64_tr_b16 v[50:51], v240 offset:8704
    s_waitcnt lgkmcnt(4)
    v_mfma_f32_32x32x16_bf16 v[12:27], v[4:7], v[92:95], v[12:27]
    v_lshl_add_u32 v253, v58, 6, v253
    v_bfe_u32 v58, v255, 4, 1
    v_lshl_add_u32 v253, v58, 5, v253
    ds_read_b64_tr_b16 v[4:5], v171 offset:8192
    ds_read_b64_tr_b16 v[6:7], v171 offset:8704
    s_waitcnt lgkmcnt(4)
    v_mfma_f32_32x32x16_bf16 v[216:231], v[60:63], v[92:95], v[216:231]
    s_setprio 0
    v_bfe_u32 v57, v56, 1, 3
    v_bfe_u32 v58, v255, 0, 2
    v_lshl_add_u32 v253, v58, 3, v253
    ds_read_b64_tr_b16 v[60:61], v240 offset:12288
    ds_read_b64_tr_b16 v[62:63], v240 offset:12800
    s_waitcnt lgkmcnt(4)
    v_mfma_f32_32x32x16_bf16 v[12:27], v[48:51], v[88:91], v[12:27]
    v_lshlrev_b32 v48, 7, v56
    v_lshl_add_u32 v48, v57, 4, v48
    s_lshl_b32 s78, s61, 12
    v_add_u32 v253, s78, v253
    v_xor_b32 v249, 64, v253
    ds_read_b64_tr_b16 v[64:65], v171 offset:12288
    ds_read_b64_tr_b16 v[66:67], v171 offset:12800
    s_waitcnt lgkmcnt(4)
    v_mfma_f32_32x32x16_bf16 v[216:231], v[4:7], v[88:91], v[216:231]
    v_and_b32 v57, 32, v255
    s_waitcnt lgkmcnt(0)
    s_barrier
    s_setprio 3
    s_cmp_lg_u32 s60, 0
    s_cbranch_scc1 LB_np_10
    buffer_load_dword v4, v245, s[52:55], s86 offen sc1
LB_np_10:
    v_add_u32 v248, 0x20000, v253
    ds_read_b64_tr_b16 v[88:89], v248 offset:16384
    ds_read_b64_tr_b16 v[90:91], v248 offset:17408
    v_mfma_f32_32x32x16_bf16 v[12:27], v[60:63], v[84:87], v[12:27]
    s_setprio 2
    s_add_u32 m0, s68, 114688
    s_add_u32 s76, s6, s71
    s_add_u32 s76, s76, 65536
    buffer_load_dwordx4 v251, s[44:47], s76 offen lds
    v_xor_b32 v48, v57, v48
    v_add_u32 v48, 0x24000, v48
    v_add_u32 v247, 0x20000, v249
    ds_read_b64_tr_b16 v[60:61], v247 offset:16384
    ds_read_b64_tr_b16 v[62:63], v247 offset:17408
    v_mfma_f32_32x32x16_bf16 v[216:231], v[64:67], v[84:87], v[216:231]
    s_setprio 1
    buffer_load_dwordx4 v250, s[44:47], s76 offen offset:1024 lds
    v_add_u32 v56, 18, v56
    ds_read_b64_tr_b16 v[64:65], v248 offset:18432
    ds_read_b64_tr_b16 v[66:67], v248 offset:19456
    s_waitcnt vmcnt(13) lgkmcnt(4)
    v_mfma_f32_32x32x16_bf16 v[200:215], v[88:91], v[8:11], 0
    s_setprio 0
    s_add_u32 m0, s68, 131072
    s_add_u32 s76, s7, s71
    s_add_u32 s76, s76, 65536
    buffer_load_dwordx4 v251, s[44:47], s76 offen lds
    v_bfe_u32 v57, v56, 1, 3
    v_lshlrev_b32 v5, 7, v56
    ds_read_b64_tr_b16 v[84:85], v247 offset:18432
    ds_read_b64_tr_b16 v[86:87], v247 offset:19456
    s_waitcnt lgkmcnt(4)
    v_mfma_f32_32x32x16_bf16 v[184:199], v[60:63], v[8:11], 0
    buffer_load_dwordx4 v250, s[44:47], s76 offen offset:1024 lds
    v_lshl_add_u32 v5, v57, 4, v5
    v_mul_f32 v12, s75, v12
    v_mul_f32 v13, s75, v13
    v_mul_f32 v14, s75, v14
    v_mul_f32 v15, s75, v15
    v_mul_f32 v16, s75, v16
    v_mul_f32 v17, s75, v17
    v_mul_f32 v18, s75, v18
    v_mul_f32 v19, s75, v19
    v_exp_f32 v12, v12
    v_exp_f32 v13, v13
    v_exp_f32 v14, v14
    v_exp_f32 v15, v15
    v_exp_f32 v16, v16
    s_waitcnt lgkmcnt(0)
    s_cmp_lg_u32 s60, 0
    s_cbranch_scc1 LB_back_9
    s_waitcnt vmcnt(4)
    v_readfirstlane_b32 s87, v4
    s_nop 0
    s_cmp_eq_u32 s87, 16
    s_cbranch_scc0 LB_slow_8
LB_back_9:
    s_barrier
    s_setprio 3
    ds_read_b64_tr_b16 v[8:9], v253
    ds_read_b64_tr_b16 v[10:11], v253 offset:1024
    s_waitcnt vmcnt(14)
    v_mfma_f32_32x32x16_bf16 v[200:215], v[64:67], v[32:35], v[200:215]
    s_setprio 2
    v_lshrrev_b32 v6, 4, v255
    s_lshl_b32 s76, s60, 2
    v_add_u32 v6, s76, v6
    v_xor_b32 v6, v6, v255
    v_and_b32 v6, 7, v6
    v_and_b32 v7, 0x3f80, v246
    v_lshl_add_u32 v7, v6, 4, v7
    s_lshl_b32 s76, s60, 10
    s_add_u32 m0, s76, 147456
    s_add_u32 s76, s76, s83
    buffer_load_dwordx4 v7, s[52:55], s76 offen sc1 lds
    v_and_b32 v57, 32, v255
    v_xor_b32 v5, v57, v5
    v_exp_f32 v17, v17
    v_exp_f32 v18, v18
    v_exp_f32 v19, v19
    v_add_f32 v12, 1.0, v12
    v_add_f32 v13, 1.0, v13
    v_add_f32 v14, 1.0, v14
    v_add_f32 v15, 1.0, v15
    v_add_f32 v16, 1.0, v16
    v_add_f32 v17, 1.0, v17
    v_add_f32 v18, 1.0, v18
    v_add_f32 v19, 1.0, v19
    v_rcp_f32 v12, v12
    v_rcp_f32 v13, v13
    ds_read_b64_tr_b16 v[56:57], v249
    ds_read_b64_tr_b16 v[58:59], v249 offset:1024
    v_mfma_f32_32x32x16_bf16 v[184:199], v[84:87], v[32:35], v[184:199]
    s_setprio 1
    s_lshr_b32 s76, s60, 1
    v_xor_b32 v6, s76, v255
    v_and_b32 v6, 7, v6
    v_lshlrev_b32 v7, 4, v6
    s_lshl_b32 s76, s60, 7
    s_add_u32 m0, s76, 155648
    s_add_u32 s76, s76, s83
    s_add_u32 s76, s76, 8192
    s_mov_b64 exec, 0xff
    buffer_load_dwordx4 v7, s[52:55], s76 offen sc1 lds
    s_mov_b64 exec, -1
    v_add_u32 v5, 0x24000, v5
    v_rcp_f32 v14, v14
    v_rcp_f32 v15, v15
    v_rcp_f32 v16, v16
    v_rcp_f32 v17, v17
    v_rcp_f32 v18, v18
    v_rcp_f32 v19, v19
    v_mul_f32 v20, v12, v20
    v_mul_f32 v21, v13, v21
    v_mul_f32 v22, v14, v22
    v_mul_f32 v23, v15, v23
    v_mul_f32 v24, v16, v24
    ds_read_b64_tr_b16 v[32:33], v253 offset:2048
    ds_read_b64_tr_b16 v[34:35], v253 offset:3072
    s_waitcnt vmcnt(14) lgkmcnt(4)
    v_mfma_f32_32x32x16_bf16 v[200:215], v[8:11], v[28:31], v[200:215]
    s_setprio 0
    v_mul_f32 v25, v17, v25
    v_mul_f32 v26, v18, v26
    v_mul_f32 v27, v19, v27
    v_cvt_pk_bf16_f32 v12, v20, v21
    v_cvt_pk_bf16_f32 v13, v22, v23
    v_cvt_pk_bf16_f32 v14, v24, v25
    v_cvt_pk_bf16_f32 v15, v26, v27
    s_add_u32 s78, s79, 32768
    buffer_store_dwordx4 v[12:15], v246, s[52:55], s78 offen sc1
    v_mul_f32 v216, s75, v216
    v_mul_f32 v217, s75, v217
    v_mul_f32 v218, s75, v218
    v_mul_f32 v219, s75, v219
    v_mul_f32 v220, s75, v220
    v_mul_f32 v221, s75, v221
    v_mul_f32 v222, s75, v222
    v_mul_f32 v223, s75, v223
    v_exp_f32 v216, v216
    v_exp_f32 v217, v217
    ds_read_b64_tr_b16 v[8:9], v249 offset:2048
    ds_read_b64_tr_b16 v[10:11], v249 offset:3072
    s_waitcnt lgkmcnt(4)
    v_mfma_f32_32x32x16_bf16 v[184:199], v[56:59], v[28:31], v[184:199]
    v_exp_f32 v218, v218
    v_exp_f32 v219, v219
    v_exp_f32 v220, v220
    v_exp_f32 v221, v221
    v_exp_f32 v222, v222
    v_exp_f32 v223, v223
    v_add_f32 v216, 1.0, v216
    v_add_f32 v217, 1.0, v217
    v_add_f32 v218, 1.0, v218
    s_waitcnt vmcnt(1) lgkmcnt(0)
    s_barrier
    s_setprio 3
    s_cmp_lg_u32 s60, 0
    s_cbranch_scc1 LB_np_18
    buffer_load_dword v6, v245, s[52:55], s85 offen offset:256 sc1
LB_np_18:
    ds_read_b64_tr_b16 v[12:13], v253 offset:16384
    ds_read_b64_tr_b16 v[14:15], v253 offset:17408
    v_mfma_f32_32x32x16_bf16 v[200:215], v[32:35], v[40:43], v[200:215]
    s_setprio 2
    s_add_u32 m0, s68, 0
    s_add_u32 s76, s26, s71
    s_add_u32 s76, s76, 65536
    buffer_load_dwordx4 v251, s[44:47], s76 offen lds
    ds_read_b128 v[16:19], v48
    v_xor_b32 v48, 16, v48
    ds_read_b128 v[20:23], v48
    v_xor_b32 v48, 0x50, v48
    ds_read_b128 v[24:27], v48
    v_add_f32 v219, 1.0, v219
    v_add_f32 v220, 1.0, v220
    v_add_f32 v221, 1.0, v221
    v_add_f32 v222, 1.0, v222
    v_add_f32 v223, 1.0, v223
    v_rcp_f32 v216, v216
    v_rcp_f32 v217, v217
    v_rcp_f32 v218, v218
    v_rcp_f32 v219, v219
    v_rcp_f32 v220, v220
    v_rcp_f32 v221, v221
    ds_read_b64_tr_b16 v[32:33], v249 offset:16384
    ds_read_b64_tr_b16 v[34:35], v249 offset:17408
    v_mfma_f32_32x32x16_bf16 v[184:199], v[8:11], v[40:43], v[184:199]
    s_setprio 1
    buffer_load_dwordx4 v250, s[44:47], s76 offen offset:1024 lds
    v_xor_b32 v48, 16, v48
    ds_read_b128 v[28:31], v48
    ds_read_b128 v[56:59], v5
    v_xor_b32 v5, 16, v5
    ds_read_b128 v[60:63], v5
    v_rcp_f32 v222, v222
    v_rcp_f32 v223, v223
    v_mul_f32 v224, v216, v224
    v_mul_f32 v225, v217, v225
    v_mul_f32 v226, v218, v226
    v_mul_f32 v227, v219, v227
    v_mul_f32 v228, v220, v228
    v_mul_f32 v229, v221, v229
    v_mul_f32 v230, v222, v230
    v_mul_f32 v231, v223, v231
    v_cvt_pk_bf16_f32 v216, v224, v225
    v_cvt_pk_bf16_f32 v217, v226, v227
    v_cvt_pk_bf16_f32 v218, v228, v229
    v_cvt_pk_bf16_f32 v219, v230, v231
    s_add_u32 s78, s79, 40960
    buffer_store_dwordx4 v[216:219], v246, s[52:55], s78 offen sc1
    ds_read_b64_tr_b16 v[8:9], v253 offset:18432
    ds_read_b64_tr_b16 v[10:11], v253 offset:19456
    s_waitcnt lgkmcnt(10)
    v_mfma_f32_32x32x16_bf16 v[200:215], v[12:15], v[0:3], v[200:215]
    s_setprio 0
    v_xor_b32 v5, 0x50, v5
    ds_read_b128 v[84:87], v5
    v_xor_b32 v5, 16, v5
    ds_read_b128 v[88:91], v5
    ds_read_b64_tr_b16 v[12:13], v249 offset:18432
    ds_read_b64_tr_b16 v[14:15], v249 offset:19456
    s_waitcnt lgkmcnt(9)
    v_mfma_f32_32x32x16_bf16 v[184:199], v[32:35], v[0:3], v[184:199]
    v_cvt_pk_bf16_f32 v16, v16, v17
    v_cvt_pk_bf16_f32 v17, v18, v19
    v_cvt_pk_bf16_f32 v18, v20, v21
    v_cvt_pk_bf16_f32 v19, v22, v23
    v_cvt_pk_bf16_f32 v24, v24, v25
    v_cvt_pk_bf16_f32 v25, v26, v27
    s_waitcnt lgkmcnt(8)
    v_cvt_pk_bf16_f32 v26, v28, v29
    v_cvt_pk_bf16_f32 v27, v30, v31
    s_waitcnt lgkmcnt(7)
    v_cvt_pk_bf16_f32 v56, v56, v57
    s_waitcnt lgkmcnt(0)
    s_cmp_lg_u32 s60, 0
    s_cbranch_scc1 LB_back_17
    s_waitcnt vmcnt(3)
    v_readfirstlane_b32 s87, v6
    s_nop 0
    s_cmp_eq_u32 s87, 8
    s_cbranch_scc0 LB_slow_16
LB_back_17:
    s_barrier
    s_setprio 3
    ds_read_b64_tr_b16 v[0:1], v253 offset:32768
    ds_read_b64_tr_b16 v[2:3], v253 offset:33792
    v_mfma_f32_32x32x16_bf16 v[200:215], v[8:11], v[44:47], v[200:215]
    s_setprio 2
    s_add_u32 m0, s68, 147456
    s_add_u32 s76, s27, s71
    s_add_u32 s76, s76, 65536
    buffer_load_dwordx4 v251, s[44:47], s76 offen lds
    v_cvt_pk_bf16_f32 v57, v58, v59
    v_cvt_pk_bf16_f32 v58, v60, v61
    v_cvt_pk_bf16_f32 v59, v62, v63
    v_cvt_pk_bf16_f32 v84, v84, v85
    v_cvt_pk_bf16_f32 v85, v86, v87
    v_cvt_pk_bf16_f32 v86, v88, v89
    v_cvt_pk_bf16_f32 v87, v90, v91
    s_lshr_b32 s78, s6, 1
    s_add_u32 s78, s78, s81
    s_add_u32 s78, s78, 65536
    buffer_load_dwordx4 v[8:11], v246, s[52:55], s78 offen sc1
    buffer_load_dwordx4 v[20:23], v246, s[52:55], s78 offen offset:1024 sc1
    ds_read_b64_tr_b16 v[28:29], v249 offset:32768
    ds_read_b64_tr_b16 v[30:31], v249 offset:33792
    v_mfma_f32_32x32x16_bf16 v[184:199], v[12:15], v[44:47], v[184:199]
    s_setprio 1
    buffer_load_dwordx4 v250, s[44:47], s76 offen offset:1024 lds
    v_mfma_f32_32x32x16_bf16 v[88:103], v[16:19], v[68:71], 0
    s_nop 11
    v_mfma_f32_32x32x16_bf16 v[100:115], v[24:27], v[76:79], 0
    s_nop 11
    v_mfma_f32_32x32x16_bf16 v[112:127], v[56:59], v[72:75], 0
    v_mfma_f32_32x32x16_bf16 v[56:71], v[84:87], v[80:83], 0
    ds_read_b64_tr_b16 v[12:13], v253 offset:34816
    ds_read_b64_tr_b16 v[14:15], v253 offset:35840
    s_waitcnt lgkmcnt(4)
    v_mfma_f32_32x32x16_bf16 v[200:215], v[0:3], v[36:39], v[200:215]
    s_setprio 0
    s_add_u32 m0, s68, 16384
    s_add_u32 s76, s3, 0
    s_and_b32 s76, s76, 1
    s_mul_i32 s76, s76, 16384
    s_add_u32 s76, s76, s73
    buffer_load_dwordx4 v251, s[44:47], s76 offen lds
    ds_read_b64_tr_b16 v[0:1], v249 offset:34816
    ds_read_b64_tr_b16 v[2:3], v249 offset:35840
    s_waitcnt lgkmcnt(4)
    v_mfma_f32_32x32x16_bf16 v[184:199], v[28:31], v[36:39], v[184:199]
    buffer_load_dwordx4 v250, s[44:47], s76 offen offset:1024 lds
    v_rcp_f32 v97, v97
    v_rcp_f32 v109, v109
    v_mul_f32 v96, v97, v96
    v_fmac_f32 v96, v109, v108
    v_add_f32 v96, 0x358637bd, v96
    v_rcp_f32 v96, v96
    s_nop 0
    v_mul_f32 v97, v96, v97
    v_mul_f32 v109, v96, v109
    v_mul_f32 v88, v97, v88
    v_mul_f32 v89, v97, v89
    v_mul_f32 v90, v97, v90
    v_mul_f32 v91, v97, v91
    v_mul_f32 v92, v97, v92
    v_mul_f32 v93, v97, v93
    v_mul_f32 v94, v97, v94
    v_mul_f32 v95, v97, v95
    v_fmac_f32 v88, v109, v100
    v_fmac_f32 v89, v109, v101
    v_fmac_f32 v90, v109, v102
    v_fmac_f32 v91, v109, v103
    s_waitcnt vmcnt(6) lgkmcnt(0)
    s_barrier
    s_setprio 3
    v_mov_b32 v4, 1
    s_cmp_lg_u32 s60, 0
    s_cbranch_scc1 LB_nosig_12
    s_mov_b64 exec, 1
    buffer_atomic_add v4, v245, s[52:55], s84 offen offset:512
    s_mov_b64 exec, -1
LB_nosig_12:
    ds_read_b64_tr_b16 v[16:17], v253 offset:49152
    ds_read_b64_tr_b16 v[18:19], v253 offset:50176
    v_mfma_f32_32x32x16_bf16 v[200:215], v[12:15], v[52:55], v[200:215]
    s_setprio 2
    s_add_u32 m0, s68, 32768
    s_add_u32 s76, s3, 1
    s_and_b32 s76, s76, 1
    s_mul_i32 s76, s76, 16384
    s_add_u32 s76, s76, s73
    buffer_load_dwordx4 v251, s[44:47], s76 offen lds
    v_fmac_f32 v92, v109, v104
    v_fmac_f32 v93, v109, v105
    v_fmac_f32 v94, v109, v106
    v_fmac_f32 v95, v109, v107
    v_cvt_pk_bf16_f32 v88, v88, v89
    v_cvt_pk_bf16_f32 v89, v90, v91
    v_cvt_pk_bf16_f32 v90, v92, v93
    v_cvt_pk_bf16_f32 v91, v94, v95
    s_add_u32 s78, s79, 114688
    buffer_store_dwordx4 v[88:91], v246, s[52:55], s78 offen sc1
    v_rcp_f32 v121, v121
    v_rcp_f32 v65, v65
    v_mul_f32 v120, v121, v120
    v_fmac_f32 v120, v65, v64
    v_add_f32 v120, 0x358637bd, v120
    v_rcp_f32 v120, v120
    s_nop 0
    v_mul_f32 v121, v120, v121
    s_lshr_b32 s78, s7, 1
    s_add_u32 s78, s78, s81
    s_add_u32 s78, s78, 65536
    buffer_load_dwordx4 v[12:15], v246, s[52:55], s78 offen sc1
    buffer_load_dwordx4 v[24:27], v246, s[52:55], s78 offen offset:1024 sc1
    ds_read_b64_tr_b16 v[28:29], v249 offset:49152
    ds_read_b64_tr_b16 v[30:31], v249 offset:50176
    v_mfma_f32_32x32x16_bf16 v[184:199], v[0:3], v[52:55], v[184:199]
    s_setprio 1
    buffer_load_dwordx4 v250, s[44:47], s76 offen offset:1024 lds
    v_mul_f32 v65, v120, v65
    v_mul_f32 v112, v121, v112
    v_mul_f32 v113, v121, v113
    v_mul_f32 v114, v121, v114
    v_mul_f32 v115, v121, v115
    v_mul_f32 v116, v121, v116
    v_mul_f32 v117, v121, v117
    v_mul_f32 v118, v121, v118
    v_mul_f32 v119, v121, v119
    v_fmac_f32 v112, v65, v56
    v_fmac_f32 v113, v65, v57
    v_fmac_f32 v114, v65, v58
    v_fmac_f32 v115, v65, v59
    v_fmac_f32 v116, v65, v60
    v_fmac_f32 v117, v65, v61
    v_fmac_f32 v118, v65, v62
    v_fmac_f32 v119, v65, v63
    v_cvt_pk_bf16_f32 v112, v112, v113
    v_cvt_pk_bf16_f32 v113, v114, v115
    v_cvt_pk_bf16_f32 v114, v116, v117
    v_cvt_pk_bf16_f32 v115, v118, v119
    s_add_u32 s78, s79, 122880
    buffer_store_dwordx4 v[112:115], v246, s[52:55], s78 offen sc1
    ds_read_b64_tr_b16 v[0:1], v253 offset:51200
    ds_read_b64_tr_b16 v[2:3], v253 offset:52224
    s_waitcnt vmcnt(10) lgkmcnt(4)
    v_mfma_f32_32x32x16_bf16 v[200:215], v[16:19], v[8:11], v[200:215]
    s_setprio 0
    ds_read_b64_tr_b16 v[16:17], v249 offset:51200
    ds_read_b64_tr_b16 v[18:19], v249 offset:52224
    s_waitcnt lgkmcnt(4)
    v_mfma_f32_32x32x16_bf16 v[184:199], v[28:31], v[8:11], v[184:199]
    s_waitcnt lgkmcnt(0)
    s_barrier
    s_setprio 3
    v_add_u32 v4, 0x10000, v253
    ds_read_b64_tr_b16 v[8:9], v4 offset:16384
    ds_read_b64_tr_b16 v[10:11], v4 offset:17408
    s_waitcnt vmcnt(9)
    v_mfma_f32_32x32x16_bf16 v[200:215], v[0:3], v[20:23], v[200:215]
    s_setprio 2
    s_add_u32 m0, s68, 49152
    s_add_u32 s76, s6, s72
    buffer_load_dwordx4 v251, s[48:51], s76 offen lds
    s_lshr_b32 s78, s26, 1
    s_add_u32 s78, s78, s81
    s_add_u32 s78, s78, 65536
    buffer_load_dwordx4 v[0:3], v246, s[52:55], s78 offen sc1
    buffer_load_dwordx4 v[28:31], v246, s[52:55], s78 offen offset:1024 sc1
    v_add_u32 v5, 0x10000, v249
    ds_read_b64_tr_b16 v[32:33], v5 offset:16384
    ds_read_b64_tr_b16 v[34:35], v5 offset:17408
    v_mfma_f32_32x32x16_bf16 v[184:199], v[16:19], v[20:23], v[184:199]
    s_setprio 1
    buffer_load_dwordx4 v250, s[48:51], s76 offen offset:1024 lds
    ds_read_b64_tr_b16 v[16:17], v4 offset:18432
    ds_read_b64_tr_b16 v[18:19], v4 offset:19456
    s_waitcnt vmcnt(7) lgkmcnt(4)
    v_mfma_f32_32x32x16_bf16 v[200:215], v[8:11], v[12:15], v[200:215]
    s_setprio 0
    ds_read_b64_tr_b16 v[8:9], v5 offset:18432
    ds_read_b64_tr_b16 v[10:11], v5 offset:19456
    s_waitcnt lgkmcnt(4)
    v_mfma_f32_32x32x16_bf16 v[184:199], v[32:35], v[12:15], v[184:199]
    s_waitcnt vmcnt(4) lgkmcnt(0)
    s_barrier
    s_setprio 3
    v_mov_b32 v6, 1
    s_cmp_lg_u32 s60, 0
    s_cbranch_scc1 LB_nosig_11
    s_mov_b64 exec, 1
    buffer_atomic_add v6, v245, s[52:55], s84 offen offset:768
    s_mov_b64 exec, -1
LB_nosig_11:
    s_cmp_lg_u32 s60, 0
    s_cbranch_scc1 LB_np_24
    buffer_load_dword v6, v245, s[52:55], s85 offen offset:512 sc1
LB_np_24:
    ds_read_b64_tr_b16 v[12:13], v4 offset:32768
    ds_read_b64_tr_b16 v[14:15], v4 offset:33792
    v_mfma_f32_32x32x16_bf16 v[200:215], v[16:19], v[24:27], v[200:215]
    s_setprio 2
    s_add_u32 m0, s68, 81920
    s_add_u32 s76, s7, s72
    buffer_load_dwordx4 v251, s[48:51], s76 offen lds
    s_lshr_b32 s78, s27, 1
    s_add_u32 s78, s78, s81
    s_add_u32 s78, s78, 65536
    buffer_load_dwordx4 v[16:19], v246, s[52:55], s78 offen sc1
    buffer_load_dwordx4 v[20:23], v246, s[52:55], s78 offen offset:1024 sc1
    ds_read_b64_tr_b16 v[32:33], v5 offset:32768
    ds_read_b64_tr_b16 v[34:35], v5 offset:33792
    v_mfma_f32_32x32x16_bf16 v[184:199], v[8:11], v[24:27], v[184:199]
    s_setprio 1
    buffer_load_dwordx4 v250, s[48:51], s76 offen offset:1024 lds
    ds_read_b64_tr_b16 v[8:9], v4 offset:34816
    ds_read_b64_tr_b16 v[10:11], v4 offset:35840
    s_waitcnt vmcnt(6) lgkmcnt(4)
    v_mfma_f32_32x32x16_bf16 v[200:215], v[12:15], v[0:3], v[200:215]
    s_setprio 0
    ds_read_b64_tr_b16 v[12:13], v5 offset:34816
    ds_read_b64_tr_b16 v[14:15], v5 offset:35840
    s_waitcnt lgkmcnt(4)
    v_mfma_f32_32x32x16_bf16 v[184:199], v[32:35], v[0:3], v[184:199]
    s_waitcnt lgkmcnt(0)
    s_cmp_lg_u32 s60, 0
    s_cbranch_scc1 LB_back_23
    s_waitcnt vmcnt(4)
    v_readfirstlane_b32 s87, v6
    s_nop 0
    s_cmp_eq_u32 s87, 16
    s_cbranch_scc0 LB_slow_22
LB_back_23:
    s_barrier
    s_setprio 3
    ds_read_b64_tr_b16 v[0:1], v4
    ds_read_b64_tr_b16 v[2:3], v4 offset:1024
    s_waitcnt vmcnt(5)
    v_mfma_f32_32x32x16_bf16 v[200:215], v[8:11], v[28:31], v[200:215]
    s_setprio 2
    s_add_u32 m0, s68, 98304
    s_add_u32 s76, s26, s72
    buffer_load_dwordx4 v251, s[48:51], s76 offen lds
    s_lshr_b32 s78, s6, 1
    s_add_u32 s78, s78, s81
    s_add_u32 s78, s78, 32768
    buffer_load_dwordx4 v[8:11], v246, s[52:55], s78 offen sc1
    buffer_load_dwordx4 v[24:27], v246, s[52:55], s78 offen offset:1024 sc1
    ds_read_b64_tr_b16 v[32:33], v5
    ds_read_b64_tr_b16 v[34:35], v5 offset:1024
    v_mfma_f32_32x32x16_bf16 v[184:199], v[12:15], v[28:31], v[184:199]
    s_setprio 1
    buffer_load_dwordx4 v250, s[48:51], s76 offen offset:1024 lds
    ds_read_b64_tr_b16 v[12:13], v4 offset:2048
    ds_read_b64_tr_b16 v[14:15], v4 offset:3072
    s_waitcnt vmcnt(6) lgkmcnt(4)
    v_mfma_f32_32x32x16_bf16 v[200:215], v[0:3], v[16:19], v[200:215]
    s_setprio 0
    ds_read_b64_tr_b16 v[0:1], v5 offset:2048
    ds_read_b64_tr_b16 v[2:3], v5 offset:3072
    s_waitcnt lgkmcnt(4)
    v_mfma_f32_32x32x16_bf16 v[184:199], v[32:35], v[16:19], v[184:199]
    s_lshr_b32 s78, s7, 1
    s_add_u32 s78, s78, s81
    s_add_u32 s78, s78, 32768
    buffer_load_dwordx4 v[16:19], v246, s[52:55], s78 offen sc1
    buffer_load_dwordx4 v[28:31], v246, s[52:55], s78 offen offset:1024 sc1
    s_waitcnt lgkmcnt(0)
    s_barrier
    s_setprio 3
    ds_read_b64_tr_b16 v[32:33], v4 offset:49152
    ds_read_b64_tr_b16 v[34:35], v4 offset:50176
    s_waitcnt vmcnt(7)
    v_mfma_f32_32x32x16_bf16 v[200:215], v[12:15], v[20:23], v[200:215]
    s_setprio 2
    s_add_u32 m0, s68, 65536
    s_add_u32 s76, s27, s72
    buffer_load_dwordx4 v251, s[48:51], s76 offen lds
    ds_read_b64_tr_b16 v[12:13], v5 offset:49152
    ds_read_b64_tr_b16 v[14:15], v5 offset:50176
    v_mfma_f32_32x32x16_bf16 v[184:199], v[0:3], v[20:23], v[184:199]
    s_setprio 1
    buffer_load_dwordx4 v250, s[48:51], s76 offen offset:1024 lds
    ds_read_b64_tr_b16 v[0:1], v4 offset:51200
    ds_read_b64_tr_b16 v[2:3], v4 offset:52224
    s_waitcnt vmcnt(6) lgkmcnt(4)
    v_mfma_f32_32x32x16_bf16 v[200:215], v[32:35], v[8:11], v[200:215]
    s_setprio 0
    s_lshr_b32 s78, s26, 1
    s_add_u32 s78, s78, s81
    s_add_u32 s78, s78, 32768
    buffer_load_dwordx4 v[20:23], v246, s[52:55], s78 offen sc1
    buffer_load_dwordx4 v[32:35], v246, s[52:55], s78 offen offset:1024 sc1
    ds_read_b64_tr_b16 v[36:37], v5 offset:51200
    ds_read_b64_tr_b16 v[38:39], v5 offset:52224
    s_waitcnt lgkmcnt(4)
    v_mfma_f32_32x32x16_bf16 v[184:199], v[12:15], v[8:11], v[184:199]
    s_waitcnt lgkmcnt(0)
    s_barrier
    s_setprio 3
    ds_read_b64_tr_b16 v[8:9], v248
    ds_read_b64_tr_b16 v[10:11], v248 offset:1024
    s_waitcnt vmcnt(7)
    v_mfma_f32_32x32x16_bf16 v[200:215], v[0:3], v[24:27], v[200:215]
    s_setprio 2
    ds_read_b64_tr_b16 v[0:1], v247
    ds_read_b64_tr_b16 v[2:3], v247 offset:1024
    v_mfma_f32_32x32x16_bf16 v[184:199], v[36:39], v[24:27], v[184:199]
    s_setprio 1
    s_lshr_b32 s78, s27, 1
    s_add_u32 s78, s78, s81
    s_add_u32 s78, s78, 32768
    buffer_load_dwordx4 v[12:15], v246, s[52:55], s78 offen sc1
    buffer_load_dwordx4 v[24:27], v246, s[52:55], s78 offen offset:1024 sc1
    ds_read_b64_tr_b16 v[36:37], v248 offset:2048
    ds_read_b64_tr_b16 v[38:39], v248 offset:3072
    s_waitcnt vmcnt(7) lgkmcnt(4)
    v_mfma_f32_32x32x16_bf16 v[200:215], v[8:11], v[16:19], v[200:215]
    s_setprio 0
    s_lshr_b32 s78, s60, 1
    s_lshl_b32 s78, s78, 3
    s_lshr_b32 s78, 151521024, s78
    s_and_b32 s78, s78, 15
    s_lshl_b32 s78, s78, 1
    s_and_b32 s89, s60, 1
    s_add_u32 s78, s78, s89
    s_lshl_b32 s78, s78, 13
    v_bfe_u32 v6, v255, 0, 5
    v_lshl_add_u32 v7, v6, 8, s78
    v_bfe_u32 v6, v255, 0, 3
    v_lshl_add_u32 v7, v6, 4, v7
    v_lshrrev_b32 v6, 5, v255
    v_lshlrev_b32 v6, 4, v6
    v_xor_b32 v7, v6, v7
    v_xor_b32 v8, 32, v7
    v_xor_b32 v9, 64, v7
    v_xor_b32 v10, 0x60, v7
    ds_read_b64_tr_b16 v[40:41], v247 offset:2048
    ds_read_b64_tr_b16 v[42:43], v247 offset:3072
    s_waitcnt lgkmcnt(4)
    v_mfma_f32_32x32x16_bf16 v[184:199], v[0:3], v[16:19], v[184:199]
    s_waitcnt lgkmcnt(0)
    s_barrier
    s_setprio 3
    s_cmp_lg_u32 s60, 0
    s_cbranch_scc1 LB_np_21
    buffer_load_dword v0, v245, s[52:55], s85 offen offset:768 sc1
LB_np_21:
    ds_read_b64_tr_b16 v[16:17], v253
    ds_read_b64_tr_b16 v[18:19], v253 offset:1024
    s_waitcnt vmcnt(6)
    v_mfma_f32_32x32x16_bf16 v[200:215], v[36:39], v[28:31], v[200:215]
    s_setprio 2
    s_add_u32 s78, s3, 0
    s_and_b32 s78, s78, 1
    s_mul_i32 s78, s78, 8192
    s_add_u32 s78, s78, 98304
    s_add_u32 s78, s78, s81
    buffer_load_dwordx4 v[36:39], v246, s[52:55], s78 offen sc1
    buffer_load_dwordx4 v[44:47], v246, s[52:55], s78 offen offset:1024 sc1
    ds_read_b64_tr_b16 v[48:49], v249
    ds_read_b64_tr_b16 v[50:51], v249 offset:1024
    v_mfma_f32_32x32x16_bf16 v[184:199], v[40:43], v[28:31], v[184:199]
    s_setprio 1
    ds_read_b64_tr_b16 v[28:29], v253 offset:2048
    ds_read_b64_tr_b16 v[30:31], v253 offset:3072
    s_waitcnt vmcnt(5) lgkmcnt(4)
    v_mfma_f32_32x32x16_bf16 v[200:215], v[16:19], v[20:23], v[200:215]
    s_setprio 0
    v_bfe_u32 v1, v255, 3, 3
    v_lshlrev_b32 v2, 8, v1
    v_bfe_u32 v1, v255, 0, 3
    v_lshl_add_u32 v2, v1, 5, v2
    v_bfe_u32 v6, v255, 3, 3
    v_lshlrev_b32 v6, 4, v6
    v_xor_b32 v2, v6, v2
    ds_read_b64_tr_b16 v[16:17], v249 offset:2048
    ds_read_b64_tr_b16 v[18:19], v249 offset:3072
    s_waitcnt lgkmcnt(4)
    v_mfma_f32_32x32x16_bf16 v[184:199], v[48:51], v[20:23], v[184:199]
    s_add_u32 s78, s3, 1
    s_and_b32 s78, s78, 1
    s_mul_i32 s78, s78, 8192
    s_add_u32 s78, s78, 98304
    s_add_u32 s78, s78, s81
    buffer_load_dwordx4 v[20:23], v246, s[52:55], s78 offen sc1
    buffer_load_dwordx4 v[40:43], v246, s[52:55], s78 offen offset:1024 sc1
    s_lshl_b32 s78, s62, 4
    s_lshr_b32 s78, 151521024, s78
    s_bfe_u32 s89, s78, 0x40008
    s_and_b32 s78, s78, 15
    s_lshl_b32 s88, s61, 11
    s_lshl_b32 s89, s89, 14
    s_add_u32 s89, s89, s88
    v_add_u32 v1, s89, v2
    s_lshl_b32 s78, s78, 14
    s_add_u32 s78, s78, s88
    v_add_u32 v2, s78, v2
    ds_read_b64_tr_b16 v[48:49], v248 offset:16384
    ds_read_b64_tr_b16 v[50:51], v248 offset:17408
    s_waitcnt vmcnt(6) lgkmcnt(4)
    v_mfma_f32_32x32x16_bf16 v[200:215], v[28:31], v[32:35], v[200:215]
    s_setprio 2
    s_lshl_b32 s78, s60, 13
    v_bfe_u32 v3, v255, 3, 3
    v_lshl_add_u32 v6, v3, 10, s78
    v_bfe_u32 v3, v255, 0, 3
    v_lshl_add_u32 v6, v3, 4, v6
    ds_read_b64_tr_b16 v[28:29], v247 offset:16384
    ds_read_b64_tr_b16 v[30:31], v247 offset:17408
    s_waitcnt lgkmcnt(4)
    v_mfma_f32_32x32x16_bf16 v[184:199], v[16:19], v[32:35], v[184:199]
    s_setprio 1
    v_xor_b32 v3, 16, v2
    v_xor_b32 v11, 16, v1
    ds_read_b64_tr_b16 v[16:17], v248 offset:18432
    ds_read_b64_tr_b16 v[18:19], v248 offset:19456
    s_waitcnt vmcnt(5) lgkmcnt(4)
    v_mfma_f32_32x32x16_bf16 v[200:215], v[48:51], v[12:15], v[200:215]
    s_setprio 0
    ds_read_b64_tr_b16 v[32:33], v247 offset:18432
    ds_read_b64_tr_b16 v[34:35], v247 offset:19456
    s_waitcnt lgkmcnt(4)
    v_mfma_f32_32x32x16_bf16 v[184:199], v[28:31], v[12:15], v[184:199]
    s_waitcnt lgkmcnt(0)
    s_cmp_lg_u32 s60, 0
    s_cbranch_scc1 LB_back_20
    s_waitcnt vmcnt(4)
    v_readfirstlane_b32 s87, v0
    s_nop 0
    s_cmp_eq_u32 s87, 8
    s_cbranch_scc0 LB_slow_19
LB_back_20:
    s_barrier
    s_setprio 3
    ds_read_b64_tr_b16 v[12:13], v253 offset:16384
    ds_read_b64_tr_b16 v[14:15], v253 offset:17408
    s_waitcnt vmcnt(4)
    v_mfma_f32_32x32x16_bf16 v[200:215], v[16:19], v[24:27], v[200:215]
    s_setprio 2
    s_lshr_b32 s78, s6, 1
    s_add_u32 s78, s78, s81
    s_add_u32 s78, s78, 114688
    buffer_load_dwordx4 v[16:19], v246, s[52:55], s78 offen sc1
    buffer_load_dwordx4 v[28:31], v246, s[52:55], s78 offen offset:1024 sc1
    ds_read_b64_tr_b16 v[48:49], v249 offset:16384
    ds_read_b64_tr_b16 v[50:51], v249 offset:17408
    v_mfma_f32_32x32x16_bf16 v[184:199], v[32:35], v[24:27], v[184:199]
    s_setprio 1
    ds_read_b64_tr_b16 v[24:25], v253 offset:18432
    ds_read_b64_tr_b16 v[26:27], v253 offset:19456
    s_waitcnt vmcnt(5) lgkmcnt(4)
    v_mfma_f32_32x32x16_bf16 v[200:215], v[12:15], v[36:39], v[200:215]
    s_setprio 0
    ds_read_b64_tr_b16 v[12:13], v249 offset:18432
    ds_read_b64_tr_b16 v[14:15], v249 offset:19456
    s_waitcnt lgkmcnt(4)
    v_mfma_f32_32x32x16_bf16 v[184:199], v[48:51], v[36:39], v[184:199]
    s_lshr_b32 s78, s7, 1
    s_add_u32 s78, s78, s81
    s_add_u32 s78, s78, 114688
    buffer_load_dwordx4 v[32:35], v246, s[52:55], s78 offen sc1
    buffer_load_dwordx4 v[36:39], v246, s[52:55], s78 offen offset:1024 sc1
    ds_read_b64_tr_b16 v[48:49], v253 offset:32768
    ds_read_b64_tr_b16 v[50:51], v253 offset:33792
    s_waitcnt vmcnt(6) lgkmcnt(4)
    v_mfma_f32_32x32x16_bf16 v[200:215], v[24:27], v[44:47], v[200:215]
    s_setprio 2
    ds_read_b64_tr_b16 v[24:25], v249 offset:32768
    ds_read_b64_tr_b16 v[26:27], v249 offset:33792
    s_waitcnt lgkmcnt(4)
    v_mfma_f32_32x32x16_bf16 v[184:199], v[12:15], v[44:47], v[184:199]
    s_setprio 1
    ds_read_b64_tr_b16 v[12:13], v253 offset:34816
    ds_read_b64_tr_b16 v[14:15], v253 offset:35840
    s_waitcnt vmcnt(5) lgkmcnt(4)
    v_mfma_f32_32x32x16_bf16 v[200:215], v[48:51], v[20:23], v[200:215]
    s_setprio 0
    s_lshr_b32 s78, s26, 1
    s_add_u32 s78, s78, s81
    s_add_u32 s78, s78, 114688
    buffer_load_dwordx4 v[44:47], v246, s[52:55], s78 offen sc1
    buffer_load_dwordx4 v[48:51], v246, s[52:55], s78 offen offset:1024 sc1
    ds_read_b64_tr_b16 v[52:53], v249 offset:34816
    ds_read_b64_tr_b16 v[54:55], v249 offset:35840
    s_waitcnt lgkmcnt(4)
    v_mfma_f32_32x32x16_bf16 v[184:199], v[24:27], v[20:23], v[184:199]
    ds_read_b64_tr_b16 v[20:21], v253 offset:49152
    ds_read_b64_tr_b16 v[22:23], v253 offset:50176
    s_waitcnt vmcnt(6) lgkmcnt(4)
    v_mfma_f32_32x32x16_bf16 v[200:215], v[12:15], v[40:43], v[200:215]
    s_setprio 2
    ds_read_b64_tr_b16 v[12:13], v249 offset:49152
    ds_read_b64_tr_b16 v[14:15], v249 offset:50176
    s_waitcnt lgkmcnt(4)
    v_mfma_f32_32x32x16_bf16 v[184:199], v[52:55], v[40:43], v[184:199]
    s_setprio 1
    s_lshr_b32 s78, s27, 1
    s_add_u32 s78, s78, s81
    s_add_u32 s78, s78, 114688
    buffer_load_dwordx4 v[24:27], v246, s[52:55], s78 offen sc1
    buffer_load_dwordx4 v[40:43], v246, s[52:55], s78 offen offset:1024 sc1
    ds_read_b64_tr_b16 v[52:53], v253 offset:51200
    ds_read_b64_tr_b16 v[54:55], v253 offset:52224
    s_waitcnt vmcnt(7) lgkmcnt(4)
    v_mfma_f32_32x32x16_bf16 v[56:71], v[20:23], v[16:19], 0
    s_setprio 0
    ds_read_b64_tr_b16 v[20:21], v249 offset:51200
    ds_read_b64_tr_b16 v[22:23], v249 offset:52224
    s_waitcnt lgkmcnt(4)
    v_mfma_f32_32x32x16_bf16 v[72:87], v[12:15], v[16:19], 0
    ds_read_b64_tr_b16 v[12:13], v4 offset:16384
    ds_read_b64_tr_b16 v[14:15], v4 offset:17408
    s_waitcnt vmcnt(6) lgkmcnt(4)
    v_mfma_f32_32x32x16_bf16 v[56:71], v[52:55], v[28:31], v[56:71]
    s_setprio 2
    ds_read_b64_tr_b16 v[16:17], v5 offset:16384
    ds_read_b64_tr_b16 v[18:19], v5 offset:17408
    s_waitcnt lgkmcnt(4)
    v_mfma_f32_32x32x16_bf16 v[72:87], v[20:23], v[28:31], v[72:87]
    s_setprio 1
    ds_read_b64_tr_b16 v[20:21], v4 offset:18432
    ds_read_b64_tr_b16 v[22:23], v4 offset:19456
    s_waitcnt vmcnt(5) lgkmcnt(4)
    v_mfma_f32_32x32x16_bf16 v[56:71], v[12:15], v[32:35], v[56:71]
    s_setprio 0
    v_sub_f32 v0, 1.0, v252
    v_mul_f32 v200, v0, v200
    v_mul_f32 v201, v0, v201
    v_mul_f32 v202, v0, v202
    v_mul_f32 v203, v0, v203
    ds_read_b64_tr_b16 v[12:13], v5 offset:18432
    ds_read_b64_tr_b16 v[14:15], v5 offset:19456
    s_waitcnt lgkmcnt(4)
    v_mfma_f32_32x32x16_bf16 v[72:87], v[16:19], v[32:35], v[72:87]
    v_mul_f32 v204, v0, v204
    v_mul_f32 v205, v0, v205
    v_mul_f32 v206, v0, v206
    v_mul_f32 v207, v0, v207
    ds_read_b64_tr_b16 v[16:17], v4 offset:32768
    ds_read_b64_tr_b16 v[18:19], v4 offset:33792
    s_waitcnt vmcnt(4) lgkmcnt(4)
    v_mfma_f32_32x32x16_bf16 v[56:71], v[20:23], v[36:39], v[56:71]
    s_setprio 2
    v_mul_f32 v208, v0, v208
    v_mul_f32 v209, v0, v209
    v_mul_f32 v210, v0, v210
    v_mul_f32 v211, v0, v211
    ds_read_b64_tr_b16 v[20:21], v5 offset:32768
    ds_read_b64_tr_b16 v[22:23], v5 offset:33792
    s_waitcnt lgkmcnt(4)
    v_mfma_f32_32x32x16_bf16 v[72:87], v[12:15], v[36:39], v[72:87]
    s_setprio 1
    v_mul_f32 v212, v0, v212
    v_mul_f32 v213, v0, v213
    v_mul_f32 v214, v0, v214
    v_mul_f32 v215, v0, v215
    ds_read_b64_tr_b16 v[12:13], v4 offset:34816
    ds_read_b64_tr_b16 v[14:15], v4 offset:35840
    s_waitcnt vmcnt(3) lgkmcnt(4)
    v_mfma_f32_32x32x16_bf16 v[56:71], v[16:19], v[44:47], v[56:71]
    s_setprio 0
    v_mul_f32 v184, v0, v184
    v_mul_f32 v185, v0, v185
    v_mul_f32 v186, v0, v186
    v_mul_f32 v187, v0, v187
    ds_read_b64_tr_b16 v[16:17], v5 offset:34816
    ds_read_b64_tr_b16 v[18:19], v5 offset:35840
    s_waitcnt lgkmcnt(4)
    v_mfma_f32_32x32x16_bf16 v[72:87], v[20:23], v[44:47], v[72:87]
    v_mul_f32 v188, v0, v188
    v_mul_f32 v189, v0, v189
    v_mul_f32 v190, v0, v190
    v_mul_f32 v191, v0, v191
    ds_read_b64_tr_b16 v[20:21], v4
    ds_read_b64_tr_b16 v[22:23], v4 offset:1024
    s_waitcnt vmcnt(2) lgkmcnt(4)
    v_mfma_f32_32x32x16_bf16 v[56:71], v[12:15], v[48:51], v[56:71]
    v_mul_f32 v192, v0, v192
    v_mul_f32 v193, v0, v193
    v_mul_f32 v194, v0, v194
    v_mul_f32 v195, v0, v195
    ds_read_b64_tr_b16 v[12:13], v4 offset:2048
    ds_read_b64_tr_b16 v[14:15], v4 offset:3072
    s_waitcnt lgkmcnt(4)
    v_mfma_f32_32x32x16_bf16 v[72:87], v[16:19], v[48:51], v[72:87]
    s_setprio 2
    v_mul_f32 v196, v0, v196
    v_mul_f32 v197, v0, v197
    v_mul_f32 v198, v0, v198
    v_mul_f32 v199, v0, v199
    ds_read_b64_tr_b16 v[16:17], v5
    ds_read_b64_tr_b16 v[18:19], v5 offset:1024
    s_waitcnt vmcnt(1) lgkmcnt(4)
    v_mfma_f32_32x32x16_bf16 v[56:71], v[20:23], v[24:27], v[56:71]
    s_setprio 1
    ds_read_b64_tr_b16 v[20:21], v5 offset:2048
    ds_read_b64_tr_b16 v[22:23], v5 offset:3072
    s_waitcnt vmcnt(0) lgkmcnt(4)
    v_mfma_f32_32x32x16_bf16 v[56:71], v[12:15], v[40:43], v[56:71]
    s_waitcnt lgkmcnt(2)
    v_mfma_f32_32x32x16_bf16 v[72:87], v[16:19], v[24:27], v[72:87]
    s_setprio 0
    s_waitcnt lgkmcnt(0)
    v_mfma_f32_32x32x16_bf16 v[72:87], v[20:23], v[40:43], v[72:87]
    s_nop 6
    v_fmac_f32 v200, v252, v56
    v_fmac_f32 v201, v252, v57
    v_fmac_f32 v202, v252, v58
    v_fmac_f32 v203, v252, v59
    ds_write_b128 v7, v[200:203]
    v_fmac_f32 v204, v252, v60
    v_fmac_f32 v205, v252, v61
    v_fmac_f32 v206, v252, v62
    v_fmac_f32 v207, v252, v63
    ds_write_b128 v8, v[204:207]
    v_fmac_f32 v208, v252, v64
    v_fmac_f32 v209, v252, v65
    v_fmac_f32 v210, v252, v66
    v_fmac_f32 v211, v252, v67
    ds_write_b128 v9, v[208:211]
    v_fmac_f32 v212, v252, v68
    v_fmac_f32 v213, v252, v69
    v_fmac_f32 v214, v252, v70
    v_fmac_f32 v215, v252, v71
    ds_write_b128 v10, v[212:215]
    v_fmac_f32 v184, v252, v72
    v_fmac_f32 v185, v252, v73
    v_fmac_f32 v186, v252, v74
    v_fmac_f32 v187, v252, v75
    ds_write_b128 v7, v[184:187] offset:128
    v_fmac_f32 v188, v252, v76
    v_fmac_f32 v189, v252, v77
    v_fmac_f32 v190, v252, v78
    v_fmac_f32 v191, v252, v79
    ds_write_b128 v8, v[188:191] offset:128
    v_fmac_f32 v192, v252, v80
    v_fmac_f32 v193, v252, v81
    v_fmac_f32 v194, v252, v82
    v_fmac_f32 v195, v252, v83
    ds_write_b128 v9, v[192:195] offset:128
    v_fmac_f32 v196, v252, v84
    v_fmac_f32 v197, v252, v85
    v_fmac_f32 v198, v252, v86
    v_fmac_f32 v199, v252, v87
    ds_write_b128 v10, v[196:199] offset:128
    s_waitcnt lgkmcnt(0)
    s_barrier
    ds_read_b128 v[12:15], v2
    ds_read_b128 v[16:19], v3
    ds_read_b128 v[20:23], v2 offset:8192
    ds_read_b128 v[24:27], v3 offset:8192
    ds_read_b128 v[28:31], v1
    ds_read_b128 v[32:35], v11
    ds_read_b128 v[36:39], v1 offset:8192
    ds_read_b128 v[0:3], v11 offset:8192
    s_waitcnt lgkmcnt(5)
    v_add_f32 v12, v12, v20
    v_add_f32 v13, v13, v21
    v_add_f32 v14, v14, v22
    v_add_f32 v15, v15, v23
    s_waitcnt lgkmcnt(4)
    v_add_f32 v16, v16, v24
    v_add_f32 v17, v17, v25
    v_add_f32 v18, v18, v26
    v_add_f32 v19, v19, v27
    s_waitcnt lgkmcnt(1)
    v_add_f32 v28, v28, v36
    v_add_f32 v29, v29, v37
    v_add_f32 v30, v30, v38
    v_add_f32 v31, v31, v39
    s_waitcnt lgkmcnt(0)
    v_add_f32 v32, v32, v0
    v_add_f32 v33, v33, v1
    v_add_f32 v34, v34, v2
    v_add_f32 v35, v35, v3
    v_add_f32 v12, v12, v28
    v_add_f32 v13, v13, v29
    v_add_f32 v14, v14, v30
    v_add_f32 v15, v15, v31
    v_add_f32 v16, v16, v32
    v_add_f32 v17, v17, v33
    v_add_f32 v18, v18, v34
    v_add_f32 v19, v19, v35
    v_cvt_pk_bf16_f32 v0, v12, v13
    v_cvt_pk_bf16_f32 v1, v14, v15
    v_cvt_pk_bf16_f32 v2, v16, v17
    v_cvt_pk_bf16_f32 v3, v18, v19
    buffer_store_dwordx4 v[0:3], v6, s[56:59], 0 offen sc1
    s_endpgm
LB_slow_3:
    s_mov_b32 s92, 4194304
LB_slow_3_l:
    global_load_dword v0, v1, s[24:25] sc1
    s_waitcnt vmcnt(0)
    v_cmp_ne_u32 vcc, 0, v0
    s_nop 1
    s_cmp_eq_u64 vcc, -1
    s_cbranch_scc1 LB_back_4
    s_sleep 6
    s_sub_u32 s92, s92, 1
    s_cmp_lg_u32 s92, 0
    s_cbranch_scc1 LB_slow_3_l
    s_branch LB_back_4
LB_slow_8:
    s_mov_b32 s92, 4194304
LB_slow_8_l:
    buffer_load_dword v4, v245, s[52:55], s86 offen sc1
    s_waitcnt vmcnt(0)
    v_readfirstlane_b32 s87, v4
    s_nop 1
    s_cmp_eq_u32 s87, 16
    s_cbranch_scc1 LB_back_9
    s_sleep 6
    s_sub_u32 s92, s92, 1
    s_cmp_lg_u32 s92, 0
    s_cbranch_scc1 LB_slow_8_l
    s_branch LB_back_9
LB_slow_13:
    s_mov_b32 s92, 4194304
LB_slow_13_l:
    buffer_load_dword v6, v245, s[52:55], s85 offen sc1
    s_waitcnt vmcnt(0)
    v_readfirstlane_b32 s87, v6
    s_nop 1
    s_cmp_eq_u32 s87, 8
    s_cbranch_scc1 LB_back_14
    s_sleep 6
    s_sub_u32 s92, s92, 1
    s_cmp_lg_u32 s92, 0
    s_cbranch_scc1 LB_slow_13_l
    s_branch LB_back_14
LB_slow_16:
    s_mov_b32 s92, 4194304
LB_slow_16_l:
    buffer_load_dword v6, v245, s[52:55], s85 offen offset:256 sc1
    s_waitcnt vmcnt(0)
    v_readfirstlane_b32 s87, v6
    s_nop 1
    s_cmp_eq_u32 s87, 8
    s_cbranch_scc1 LB_back_17
    s_sleep 6
    s_sub_u32 s92, s92, 1
    s_cmp_lg_u32 s92, 0
    s_cbranch_scc1 LB_slow_16_l
    s_branch LB_back_17
LB_slow_19:
    s_mov_b32 s92, 4194304
LB_slow_19_l:
    buffer_load_dword v0, v245, s[52:55], s85 offen offset:768 sc1
    s_waitcnt vmcnt(0)
    v_readfirstlane_b32 s87, v0
    s_nop 1
    s_cmp_eq_u32 s87, 8
    s_cbranch_scc1 LB_back_20
    s_sleep 6
    s_sub_u32 s92, s92, 1
    s_cmp_lg_u32 s92, 0
    s_cbranch_scc1 LB_slow_19_l
    s_branch LB_back_20
LB_slow_22:
    s_mov_b32 s92, 4194304
LB_slow_22_l:
    buffer_load_dword v6, v245, s[52:55], s85 offen offset:512 sc1
    s_waitcnt vmcnt(0)
    v_readfirstlane_b32 s87, v6
    s_nop 1
    s_cmp_eq_u32 s87, 16
    s_cbranch_scc1 LB_back_23
    s_sleep 6
    s_sub_u32 s92, s92, 1
    s_cmp_lg_u32 s92, 0
    s_cbranch_scc1 LB_slow_22_l
    s_branch LB_back_23
LB_end:
.section .rodata,"a"
.p2align 6
.amdhsa_kernel gated_mix__linear_kernel_hedgehog__glu_gated_glu__prompt_kernel
  .amdhsa_next_free_vgpr 256
  .amdhsa_next_free_sgpr 102
  .amdhsa_accum_offset 256
  .amdhsa_group_segment_fixed_size 0
  .amdhsa_kernarg_size 96
  .amdhsa_user_sgpr_count 2
  .amdhsa_user_sgpr_kernarg_segment_ptr 1
  .amdhsa_system_sgpr_workgroup_id_x 1
.end_amdhsa_kernel
```
